```python
import torch

def _softmax(x, axis=-1):
    return torch.softmax(x, dim=axis)
def _gelu(x):
    return torch.nn.functional.gelu(x, approximate="tanh")
def _silu(x):
    return torch.nn.functional.silu(x)
def _sigmoid(x):
    return torch.sigmoid(x)
def _layernorm(x, axis=-1, eps=1e-5):
    m = x.mean(dim=axis, keepdim=True)
    v = x.var(dim=axis, keepdim=True, unbiased=False)
    return (x - m) / torch.sqrt(v + eps)
def _scatter_add(tgt, idx, src, axis=0):
    return tgt.clone().index_add_(axis, idx, src)
def _segment_sum(src, seg, n):
    out = torch.zeros((n,) + src.shape[1:], dtype=src.dtype)
    return out.index_add_(0, seg, src)
def _pad(x, pw):
    flat = tuple(v for pair in reversed(pw) for v in pair)
    return torch.nn.functional.pad(x, flat)

kernel_name = 'parallel_sum__gqa_block_cached__geglu_ffn__decode'

def setup_inputs():

    _w = (lambda a: (lambda t: t.to(torch.bfloat16) if t.is_floating_point() else t)(torch.as_tensor(a)))
    def _A_setup():
        B, Sq, D = 2, 1, 512
        Hq, Hkv, Sk, Dh = 32, 8, 32768, 128
        assert Hq % Hkv == 0, (Hq, Hkv)
        return {
            "x": _w((lambda *s: torch.randn(*s, dtype=torch.bfloat16) * 0.05)(B, Sq, D)),
            "k_cache": _w((lambda *s: torch.randn(*s, dtype=torch.bfloat16) * 3.2)(B, Hkv, Sk, Dh)),
            "v_cache": _w((lambda *s: torch.randn(*s, dtype=torch.bfloat16) * 1.6)(B, Hkv, Sk, Dh)),
            "wq": _w((lambda *s: torch.randn(*s, dtype=torch.bfloat16) * 3.2)(D, Hq * Dh) * (D ** -0.5)),
            "wo": _w((lambda *s: torch.randn(*s, dtype=torch.bfloat16) * 1.6)(Hq * Dh, D) * ((Hq * Dh) ** -0.5)),
        }
    _A_in = _A_setup()

    def _B_setup():
        B, S, D, F = 2, 1, 512, 1792
        return {
            "x": _w((lambda *s: torch.randn(*s, dtype=torch.bfloat16) * 0.05)(B, S, D)),
            "w_gate": _w((lambda *s: torch.randn(*s, dtype=torch.bfloat16) * 0.05)(D, F)),
            "w_up": _w((lambda *s: torch.randn(*s, dtype=torch.bfloat16) * 0.05)(D, F)),
            "w_down": _w((lambda *s: torch.randn(*s, dtype=torch.bfloat16) * 0.05)(F, D)),
        }
    _B_in = _B_setup()

    return {
        "A_x": _A_in["x"],
        "A_k_cache": _A_in["k_cache"],
        "A_v_cache": _A_in["v_cache"],
        "A_wq": _A_in["wq"],
        "A_wo": _A_in["wo"],
        "B_x": _B_in["x"],
        "B_w_gate": _B_in["w_gate"],
        "B_w_up": _B_in["w_up"],
        "B_w_down": _B_in["w_down"],
    }

def reference(A_x, A_k_cache, A_v_cache, A_wq, A_wo, B_x, B_w_gate, B_w_up, B_w_down):
    def _A_ref(x, k_cache, v_cache, wq, wo):
        B, Sq, D = x.shape
        Hq, Dh = 32, 128
        Hkv = k_cache.shape[1]
        rep = Hq // Hkv
        q = (lambda x, *d: x.permute(*d))((x @ wq).reshape(B, Sq, Hq, Dh), 0, 2, 1, 3)
        k = (lambda x, n, axis: torch.repeat_interleave(x, n, dim=axis))(k_cache, rep, axis=1)
        v = (lambda x, n, axis: torch.repeat_interleave(x, n, dim=axis))(v_cache, rep, axis=1)
        scores = torch.einsum("bhqd,bhkd->bhqk", q, k) * (Dh ** -0.5)
        p = _softmax(scores, axis=-1)
        o = torch.einsum("bhqk,bhkd->bhqd", p, v)
        return (lambda x, *d: x.permute(*d))(o, 0, 2, 1, 3).reshape(B, Sq, Hq * Dh) @ wo

    def _B_ref(x, w_gate, w_up, w_down):
        return (_gelu(x @ w_gate) * (x @ w_up)) @ w_down

    x = A_x
    xn = _layernorm(x, axis=-1)
    return x + _A_ref(xn, A_k_cache, A_v_cache, A_wq, A_wo) + _B_ref(xn, B_w_gate, B_w_up, B_w_down)
```

```asm
; @launch grid=(256,1,1) block=(512,1,1) lds=58368
.amdgcn_target "amdgcn-amd-amdhsa--gfx950"
.text
.globl parallel_sum__gqa_block_cached__geglu_ffn__decode_kernel
.p2align 12
.p2align 8
.type parallel_sum__gqa_block_cached__geglu_ffn__decode_kernel,@function
parallel_sum__gqa_block_cached__geglu_ffn__decode_kernel:
    s_load_dwordx2 s[4:5], s[0:1], 24
    s_load_dwordx4 s[52:55], s[0:1], 48
    s_load_dwordx4 s[56:59], s[0:1], 64
    s_load_dwordx2 s[8:9], s[0:1], 8
    s_load_dwordx2 s[16:17], s[0:1], 88
    v_lshrrev_b32 v3, 6, v0
    s_cmp_ge_u32 s2, 256
    s_cbranch_scc1 L_end0
    v_readfirstlane_b32 s3, v3
    v_and_b32 v0, 63, v0
    s_mov_b32 s51, 0
    s_mov_b32 s18, 0x200000
    s_mov_b32 s19, 0x20000
    s_and_b32 s6, s2, 15
    s_lshr_b32 s7, s2, 4
    s_and_b32 s43, s2, 7
    s_lshr_b32 s30, s2, 6
    s_bfe_u32 s31, s2, 0x20004
    s_lshl_b32 s32, s43, 2
    s_add_u32 s32, s32, s30
    s_lshl_b32 s35, s43, 1
    s_and_b32 s30, s30, 1
    s_or_b32 s30, s30, s35
    s_bitcmp1_b32 s2, 3
    s_cselect_b32 s32, s30, s32
    s_bfe_u32 s41, s2, 0x20003
    s_and_b32 s42, s2, 7
    s_lshl_b32 s42, s42, 3
    s_lshr_b32 s29, s2, 5
    s_or_b32 s42, s42, s29
    s_cmp_lt_u32 s3, 4
    s_cbranch_scc1 L_str0
    v_mov_b32 v4, 0
    v_lshlrev_b32 v2, 2, v0
    ds_write_b32 v2, v4 offset:0
    v_mov_b32 v5, 2
    ds_write_b32 v2, v5 offset:256
    v_lshlrev_b32 v5, 4, v0
    ds_write_b32 v5, v4 offset:16384
    s_load_dwordx2 s[24:25], s[0:1], 0
    s_load_dwordx2 s[84:85], s[0:1], 80
    s_waitcnt lgkmcnt(0)
    s_barrier
    s_branch L_helper
L_end0:
    s_endpgm
L_str0:
    s_bitcmp1_b32 s2, 3
    s_cselect_b32 s33, 3584, 0
    s_cselect_b32 s22, 1835008, 0
    s_cmp_eq_u32 s6, 15
    s_cselect_b32 s22, 0, s22
    s_bitcmp0_b32 s2, 3
    s_cselect_b32 s33, 8192, s33
    s_cselect_b32 s22, 0x400000, s22
    s_lshl_b32 s30, s31, 7
    s_add_u32 s30, s30, s3
    s_mul_i32 s30, s30, s33
    s_lshl_b32 s29, s32, 8
    s_add_u32 s30, s30, s29
    v_lshrrev_b32 v3, 4, v0
    v_and_b32 v5, 15, v0
    v_lshlrev_b32 v5, 4, v5
    s_lshl_b32 s29, s33, 5
    v_mad_u32_u24 v4, v3, s29, v5
    v_lshl_add_u32 v5, v3, 13, v5
    s_lshl_b32 s33, s33, 2
    s_mov_b32 s23, 0x20000
    s_mov_b32 s15, 0x20000
    s_lshl_b32 s29, s3, 10
    s_add_u32 m0, s29, 17408
    s_waitcnt lgkmcnt(0)
    s_bitcmp1_b32 s2, 7
    s_cselect_b32 s20, s54, s52
    s_cselect_b32 s21, s55, s53
    s_bitcmp0_b32 s2, 3
    s_cselect_b32 s20, s4, s20
    s_cselect_b32 s21, s5, s21
    buffer_load_dwordx4 v4, s[20:23], s30 offen nt lds
    s_add_u32 m0, m0, 4096
    s_add_u32 s30, s30, s33
    buffer_load_dwordx4 v4, s[20:23], s30 offen nt lds
    s_add_u32 m0, m0, 4096
    s_add_u32 s30, s30, s33
    buffer_load_dwordx4 v4, s[20:23], s30 offen nt lds
    s_add_u32 m0, m0, 4096
    s_add_u32 s30, s30, s33
    buffer_load_dwordx4 v4, s[20:23], s30 offen nt lds
    s_add_u32 m0, m0, 4096
    s_add_u32 s30, s30, s33
    buffer_load_dwordx4 v4, s[20:23], s30 offen nt lds
    s_add_u32 m0, m0, 4096
    s_add_u32 s30, s30, s33
    buffer_load_dwordx4 v4, s[20:23], s30 offen nt lds
    s_add_u32 m0, m0, 4096
    s_add_u32 s30, s30, s33
    buffer_load_dwordx4 v4, s[20:23], s30 offen nt lds
    s_add_u32 m0, m0, 4096
    s_add_u32 s30, s30, s33
    s_setprio 2
    s_lshl_b32 s26, s6, 23
    s_lshl_b32 s29, s3, 12
    s_or_b32 s26, s26, s29
    s_bfe_u32 s29, s7, 0x10000
    s_lshl_b32 s29, s29, 15
    s_or_b32 s26, s26, s29
    s_bfe_u32 s29, s7, 0x20001
    s_lshl_b32 s29, s29, 17
    s_or_b32 s26, s26, s29
    s_bfe_u32 s29, s7, 0x10003
    s_lshl_b32 s29, s29, 21
    s_or_b32 s26, s26, s29
    s_mov_b32 s28, s26
    v_and_b32 v1, 3, v0
    v_lshlrev_b32 v1, 4, v1
    v_lshl_add_u32 v1, v3, 6, v1
    v_bfe_u32 v3, v0, 2, 2
    v_lshl_add_u32 v1, v3, 8, v1
    s_mov_b32 s10, 0x8000000
    s_mov_b32 s11, 0x20000
    s_mov_b32 s12, s56
    s_mov_b32 s13, s57
    s_cmp_lt_u32 s42, 56
    s_cselect_b32 s14, 1835008, 0
    s_lshl_b32 s34, s42, 15
    s_lshl_b32 s29, s41, 8
    s_add_u32 s34, s34, s29
    s_lshl_b32 s35, s3, 11
    s_add_u32 s34, s34, s35
    s_lshl_b32 s29, s3, 8
    v_lshl_add_u32 v76, v0, 2, s29
    buffer_load_dwordx4 v4, s[20:23], s30 offen nt lds
    s_add_u32 m0, s35, 50176
    s_nop 0
    buffer_load_dwordx4 v5, s[12:15], s34 offen offset:0 nt lds
    buffer_load_dwordx4 v5, s[12:15], s34 offen offset:1024 nt lds
    s_load_dwordx2 s[90:91], s[0:1], 16
    s_load_dwordx2 s[92:93], s[0:1], 32
    s_barrier
    s_waitcnt vmcnt(5)
    buffer_load_dwordx4 v[80:83], v1, s[8:11], s28 offen nt
    s_xor_b32 s28, s26, 0x80400
    s_waitcnt vmcnt(5)
    buffer_load_dwordx4 v[84:87], v1, s[8:11], s28 offen nt
    s_xor_b32 s28, s26, 0x800
    s_waitcnt vmcnt(5)
    buffer_load_dwordx4 v[88:91], v1, s[8:11], s28 offen nt
    s_xor_b32 s28, s26, 0x80c00
    s_waitcnt vmcnt(5)
    buffer_load_dwordx4 v[92:95], v1, s[8:11], s28 offen nt
    s_xor_b32 s28, s26, 0x4000
    s_waitcnt vmcnt(5)
    buffer_load_dwordx4 v[96:99], v1, s[8:11], s28 offen nt
    s_xor_b32 s28, s26, 0x84400
    s_waitcnt vmcnt(5)
    buffer_load_dwordx4 v[100:103], v1, s[8:11], s28 offen nt
    s_xor_b32 s28, s26, 0x4800
    v_mov_b32 v79, 1
    ds_write_b32 v76, v79 offset:16384
    s_waitcnt vmcnt(5)
    buffer_load_dwordx4 v[104:107], v1, s[8:11], s28 offen nt
    s_xor_b32 s28, s26, 0x84c00
    s_waitcnt vmcnt(5)
    buffer_load_dwordx4 v[108:111], v1, s[8:11], s28 offen nt
    s_xor_b32 s28, s26, 0x10000
    s_waitcnt vmcnt(5)
    buffer_load_dwordx4 v[112:115], v1, s[8:11], s28 offen nt
    s_xor_b32 s28, s26, 0x90400
    s_waitcnt vmcnt(5)
    buffer_load_dwordx4 v[116:119], v1, s[8:11], s28 offen nt
    s_xor_b32 s28, s26, 0x10800
    s_waitcnt vmcnt(5)
    buffer_load_dwordx4 v[120:123], v1, s[8:11], s28 offen nt
    s_xor_b32 s28, s26, 0x90c00
    s_waitcnt vmcnt(5)
    buffer_load_dwordx4 v[124:127], v1, s[8:11], s28 offen nt
    s_xor_b32 s28, s26, 0x14000
    s_branch L_stream
L_helper:
    s_mov_b32 s26, 0x800
    s_mov_b32 s27, 0x20000
    s_mov_b32 s23, 0x20000
    s_mov_b32 s86, 0x100
    s_mov_b32 s87, 0x20000
    s_getreg_b32 s89, hwreg(HW_REG_XCC_ID)
    s_and_b32 s89, s89, 7
    s_add_u32 s89, s89, 1
    s_lshl_b32 s88, s43, 5
    s_cmp_eq_u32 s3, 4
    s_cbranch_scc1 L_h0
    s_cmp_eq_u32 s3, 7
    s_cbranch_scc1 L_h3
    s_cmp_eq_u32 s3, 5
    s_cbranch_scc1 L_h1
    s_lshr_b32 s29, s2, 3
    v_mov_b32 v4, s29
    v_mov_b32 v5, s89
    s_mov_b64 exec, 1
    buffer_store_byte v5, v4, s[84:87], s88 offen
    s_mov_b64 exec, -1
    s_branch L_h2pre
L_h0:
    v_lshlrev_b32 v2, 4, v0
    buffer_load_dwordx4 v[4:7], v2, s[24:27], 0 offen
    buffer_load_dwordx4 v[8:11], v2, s[24:27], 0 offen offset:1024
    v_mov_b32 v78, 0
    buffer_load_dword v78, v78, s[16:19], 0 offen offset:0 sc1
    s_cmp_eq_u32 s6, 15
    s_cbranch_scc1 L_h0skip
    s_lshr_b32 s35, s2, 7
    s_lshl_b32 s35, s35, 10
    s_lshl_b32 s34, s32, 13
    s_add_u32 s34, s34, s35
    s_lshl_b32 s35, s31, 7
    s_add_u32 s34, s34, s35
    s_add_u32 s34, s34, 196608
    s_lshl_b32 s33, s32, 11
    s_lshl_b32 s35, s31, 9
    s_add_u32 s33, s33, s35
    s_add_u32 s33, s33, 65536
    s_bitcmp1_b32 s2, 3
    s_cselect_b32 s34, s34, s33
    s_cselect_b32 s44, 11, 6
    s_cselect_b32 s45, 9, 16
    s_cselect_b32 s46, 6, 8
    v_and_b32 v76, 3, v0
    v_lshlrev_b32 v76, 4, v76
    v_bfe_u32 v28, v0, 2, 2
    v_lshl_add_u32 v76, v28, s44, v76
    v_bfe_u32 v28, v0, 4, 1
    v_lshl_add_u32 v76, v28, s45, v76
    v_lshrrev_b32 v28, 5, v0
    v_lshl_add_u32 v76, v28, s46, v76
    buffer_load_dword v80, v76, s[16:19], s34 offen sc1
    v_and_b32 v28, 1, v0
    v_cmp_eq_u32 vcc, 1, v28
    v_mov_b32 v29, 0x0c0c0100
    v_mov_b32 v30, 0x01000c0c
    v_cndmask_b32 v29, v29, v30, vcc
    v_mov_b32 v30, 0x0c0c0302
    v_mov_b32 v31, 0x03020c0c
    v_cndmask_b32 v30, v30, v31, vcc
    v_bfe_u32 v28, v0, 3, 1
    v_bfe_u32 v31, v0, 1, 1
    v_lshl_add_u32 v28, v28, 1, v31
    v_mov_b32 v31, 0x0c0c0c0c
    v_cmp_eq_u32 vcc, 0, v28
    s_nop 1
    v_cndmask_b32 v40, v31, v29, vcc
    v_cndmask_b32 v41, v31, v30, vcc
    v_cmp_eq_u32 vcc, 1, v28
    s_nop 1
    v_cndmask_b32 v42, v31, v29, vcc
    v_cndmask_b32 v43, v31, v30, vcc
    v_cmp_eq_u32 vcc, 2, v28
    s_nop 1
    v_cndmask_b32 v44, v31, v29, vcc
    v_cndmask_b32 v45, v31, v30, vcc
    v_cmp_eq_u32 vcc, 3, v28
    s_nop 1
    v_cndmask_b32 v46, v31, v29, vcc
    v_cndmask_b32 v47, v31, v30, vcc
    s_waitcnt vmcnt(1)
    v_lshlrev_b32 v12, 16, v4
    v_and_b32 v13, 0xffff0000, v4
    v_lshlrev_b32 v14, 16, v5
    v_and_b32 v15, 0xffff0000, v5
    v_lshlrev_b32 v16, 16, v6
    v_and_b32 v17, 0xffff0000, v6
    v_lshlrev_b32 v18, 16, v7
    v_and_b32 v19, 0xffff0000, v7
    v_lshlrev_b32 v20, 16, v8
    v_and_b32 v21, 0xffff0000, v8
    v_lshlrev_b32 v22, 16, v9
    v_and_b32 v23, 0xffff0000, v9
    v_lshlrev_b32 v24, 16, v10
    v_and_b32 v25, 0xffff0000, v10
    v_lshlrev_b32 v26, 16, v11
    v_and_b32 v27, 0xffff0000, v11
    v_add_f32 v28, v12, v13
    v_add_f32 v29, v20, v21
    v_add_f32 v28, v28, v14
    v_add_f32 v29, v29, v22
    v_add_f32 v28, v28, v15
    v_add_f32 v29, v29, v23
    v_add_f32 v28, v28, v16
    v_add_f32 v29, v29, v24
    v_add_f32 v28, v28, v17
    v_add_f32 v29, v29, v25
    v_add_f32 v28, v28, v18
    v_add_f32 v29, v29, v26
    v_add_f32 v28, v28, v19
    v_add_f32 v29, v29, v27
    s_nop 1
    v_permlane32_swap_b32 v28, v29
    v_add_f32 v28, v28, v29
    v_mov_b32 v30, v28
    s_nop 1
    v_permlane16_swap_b32 v30, v28
    v_add_f32 v28, v28, v30
    s_nop 1
    v_add_f32_dpp v28, v28, v28 row_ror:1 row_mask:0xf bank_mask:0xf
    s_nop 1
    v_add_f32_dpp v28, v28, v28 row_ror:2 row_mask:0xf bank_mask:0xf
    s_nop 1
    v_add_f32_dpp v28, v28, v28 row_ror:4 row_mask:0xf bank_mask:0xf
    s_nop 1
    v_add_f32_dpp v28, v28, v28 row_ror:8 row_mask:0xf bank_mask:0xf
    v_mul_f32 v28, 0x3b000000, v28
    s_nop 0
    v_readlane_b32 s52, v28, 0
    v_readlane_b32 s53, v28, 32
    v_cvt_pk_bf16_f32 v31, v28, v28
    v_and_b32 v31, 0xffff0000, v31
    v_subrev_f32 v32, s52, v12
    v_mul_f32 v34, v32, v32
    v_subrev_f32 v33, s53, v20
    v_mul_f32 v35, v33, v33
    v_subrev_f32 v32, s52, v13
    v_fmac_f32 v34, v32, v32
    v_subrev_f32 v33, s53, v21
    v_fmac_f32 v35, v33, v33
    v_subrev_f32 v32, s52, v14
    v_fmac_f32 v34, v32, v32
    v_subrev_f32 v33, s53, v22
    v_fmac_f32 v35, v33, v33
    v_subrev_f32 v32, s52, v15
    v_fmac_f32 v34, v32, v32
    v_subrev_f32 v33, s53, v23
    v_fmac_f32 v35, v33, v33
    v_subrev_f32 v32, s52, v16
    v_fmac_f32 v34, v32, v32
    v_subrev_f32 v33, s53, v24
    v_fmac_f32 v35, v33, v33
    v_subrev_f32 v32, s52, v17
    v_fmac_f32 v34, v32, v32
    v_subrev_f32 v33, s53, v25
    v_fmac_f32 v35, v33, v33
    v_subrev_f32 v32, s52, v18
    v_fmac_f32 v34, v32, v32
    v_subrev_f32 v33, s53, v26
    v_fmac_f32 v35, v33, v33
    v_subrev_f32 v32, s52, v19
    v_fmac_f32 v34, v32, v32
    v_subrev_f32 v33, s53, v27
    v_fmac_f32 v35, v33, v33
    s_nop 1
    v_permlane32_swap_b32 v34, v35
    v_add_f32 v34, v34, v35
    v_mov_b32 v30, v34
    s_nop 1
    v_permlane16_swap_b32 v30, v34
    v_add_f32 v34, v34, v30
    s_nop 1
    v_add_f32_dpp v34, v34, v34 row_ror:1 row_mask:0xf bank_mask:0xf
    s_nop 1
    v_add_f32_dpp v34, v34, v34 row_ror:2 row_mask:0xf bank_mask:0xf
    s_nop 1
    v_add_f32_dpp v34, v34, v34 row_ror:4 row_mask:0xf bank_mask:0xf
    s_nop 1
    v_add_f32_dpp v34, v34, v34 row_ror:8 row_mask:0xf bank_mask:0xf
    v_mul_f32 v34, 0x3b000000, v34
    v_cvt_pk_bf16_f32 v34, v34, v34
    v_and_b32 v34, 0xffff0000, v34
    v_add_f32 v34, 0x3727c5ac, v34
    v_cvt_pk_bf16_f32 v34, v34, v34
    v_and_b32 v34, 0xffff0000, v34
    v_sqrt_f32 v34, v34
    s_nop 0
    v_cvt_pk_bf16_f32 v34, v34, v34
    v_and_b32 v34, 0xffff0000, v34
    v_rcp_f32 v34, v34
    v_readlane_b32 s54, v31, 0
    v_readlane_b32 s55, v31, 32
    v_readlane_b32 s56, v34, 0
    v_readlane_b32 s57, v34, 32
    v_subrev_f32 v12, s54, v12
    v_subrev_f32 v13, s54, v13
    v_subrev_f32 v14, s54, v14
    v_subrev_f32 v15, s54, v15
    v_subrev_f32 v16, s54, v16
    v_subrev_f32 v17, s54, v17
    v_subrev_f32 v18, s54, v18
    v_subrev_f32 v19, s54, v19
    v_cvt_pk_bf16_f32 v4, v12, v13
    v_cvt_pk_bf16_f32 v5, v14, v15
    v_cvt_pk_bf16_f32 v6, v16, v17
    v_cvt_pk_bf16_f32 v7, v18, v19
    v_lshlrev_b32 v12, 16, v4
    v_and_b32 v13, 0xffff0000, v4
    v_lshlrev_b32 v14, 16, v5
    v_and_b32 v15, 0xffff0000, v5
    v_lshlrev_b32 v16, 16, v6
    v_and_b32 v17, 0xffff0000, v6
    v_lshlrev_b32 v18, 16, v7
    v_and_b32 v19, 0xffff0000, v7
    v_mul_f32 v12, s56, v12
    v_mul_f32 v13, s56, v13
    v_mul_f32 v14, s56, v14
    v_mul_f32 v15, s56, v15
    v_mul_f32 v16, s56, v16
    v_mul_f32 v17, s56, v17
    v_mul_f32 v18, s56, v18
    v_mul_f32 v19, s56, v19
    v_cvt_pk_bf16_f32 v4, v12, v13
    v_cvt_pk_bf16_f32 v5, v14, v15
    v_cvt_pk_bf16_f32 v6, v16, v17
    v_cvt_pk_bf16_f32 v7, v18, v19
    ds_write_b128 v2, v[4:7] offset:2048
    v_subrev_f32 v20, s55, v20
    v_subrev_f32 v21, s55, v21
    v_subrev_f32 v22, s55, v22
    v_subrev_f32 v23, s55, v23
    v_subrev_f32 v24, s55, v24
    v_subrev_f32 v25, s55, v25
    v_subrev_f32 v26, s55, v26
    v_subrev_f32 v27, s55, v27
    v_cvt_pk_bf16_f32 v8, v20, v21
    v_cvt_pk_bf16_f32 v9, v22, v23
    v_cvt_pk_bf16_f32 v10, v24, v25
    v_cvt_pk_bf16_f32 v11, v26, v27
    v_lshlrev_b32 v20, 16, v8
    v_and_b32 v21, 0xffff0000, v8
    v_lshlrev_b32 v22, 16, v9
    v_and_b32 v23, 0xffff0000, v9
    v_lshlrev_b32 v24, 16, v10
    v_and_b32 v25, 0xffff0000, v10
    v_lshlrev_b32 v26, 16, v11
    v_and_b32 v27, 0xffff0000, v11
    v_mul_f32 v20, s57, v20
    v_mul_f32 v21, s57, v21
    v_mul_f32 v22, s57, v22
    v_mul_f32 v23, s57, v23
    v_mul_f32 v24, s57, v24
    v_mul_f32 v25, s57, v25
    v_mul_f32 v26, s57, v26
    v_mul_f32 v27, s57, v27
    v_cvt_pk_bf16_f32 v8, v20, v21
    v_cvt_pk_bf16_f32 v9, v22, v23
    v_cvt_pk_bf16_f32 v10, v24, v25
    v_cvt_pk_bf16_f32 v11, v26, v27
    ds_write_b128 v2, v[8:11] offset:3072
L_pad0:
    s_cmp_eq_u32 s51, 1
    s_cbranch_scc1 L_pad1
    v_bfe_u32 v28, v0, 2, 1
    v_lshlrev_b32 v28, 10, v28
    v_lshrrev_b32 v29, 4, v0
    v_lshl_add_u32 v28, v29, 6, v28
    s_lshl_b32 s30, s31, 8
    v_add_u32 v28, s30, v28
    ds_read_b128 v[48:51], v28 offset:2048
    ds_read_b128 v[52:55], v28 offset:2064
    ds_read_b128 v[56:59], v28 offset:2080
    ds_read_b128 v[60:63], v28 offset:2096
    v_mov_b32 v77, 0xfffffff0
    v_readfirstlane_b32 s36, v78
    s_nop 0
    s_add_u32 s36, s36, 0x01010101
    s_bfe_u32 s37, s36, 0x40000
    s_bfe_u32 s38, s36, 0x40008
    s_bfe_u32 s39, s36, 0x40010
    s_bfe_u32 s40, s36, 0x40018
    v_and_b32 v79, 7, v0
    v_lshlrev_b32 v79, 2, v79
    buffer_load_dword v79, v79, s[84:87], s88 offen sc1
    s_mov_b32 s50, 524288
    v_and_b32 v28, 3, v0
    v_lshlrev_b32 v28, 8, v28
L_ww0:
    ds_read_b32 v29, v28 offset:16384
    s_waitcnt lgkmcnt(0)
    v_cmp_eq_u32 vcc, 0, v29
    s_cbranch_vccz L_ww0x
    s_sleep 1
    s_sub_u32 s50, s50, 1
    s_cbranch_scc0 L_ww0
L_ww0x:
    ds_read_b128 v[128:131], v2 offset:17408
    ds_read_b128 v[132:135], v2 offset:18432
    ds_read_b128 v[136:139], v2 offset:19456
    ds_read_b128 v[140:143], v2 offset:20480
    ds_read_b128 v[144:147], v2 offset:21504
    ds_read_b128 v[148:151], v2 offset:22528
    v_perm_b32 v64, v48, v48, v40
    v_perm_b32 v65, v48, v48, v42
    v_perm_b32 v66, v48, v48, v44
    v_perm_b32 v67, v48, v48, v46
    s_waitcnt lgkmcnt(5)
    ds_read_b128 v[152:155], v2 offset:23552
    v_mfma_f32_16x16x32_bf16 v[72:75], v[64:67], v[128:131], 0
    v_perm_b32 v68, v48, v48, v41
    v_perm_b32 v69, v48, v48, v43
    v_perm_b32 v70, v48, v48, v45
    v_perm_b32 v71, v48, v48, v47
    s_waitcnt lgkmcnt(5)
    ds_read_b128 v[156:159], v2 offset:24576
    v_mfma_f32_16x16x32_bf16 v[72:75], v[68:71], v[132:135], v[72:75]
    v_perm_b32 v64, v49, v49, v40
    v_perm_b32 v65, v49, v49, v42
    v_perm_b32 v66, v49, v49, v44
    v_perm_b32 v67, v49, v49, v46
    s_waitcnt lgkmcnt(5)
    ds_read_b128 v[160:163], v2 offset:25600
    v_mfma_f32_16x16x32_bf16 v[72:75], v[64:67], v[136:139], v[72:75]
    v_perm_b32 v68, v49, v49, v41
    v_perm_b32 v69, v49, v49, v43
    v_perm_b32 v70, v49, v49, v45
    v_perm_b32 v71, v49, v49, v47
    s_waitcnt lgkmcnt(5)
    ds_read_b128 v[164:167], v2 offset:26624
    v_mfma_f32_16x16x32_bf16 v[72:75], v[68:71], v[140:143], v[72:75]
    v_perm_b32 v64, v50, v50, v40
    v_perm_b32 v65, v50, v50, v42
    v_perm_b32 v66, v50, v50, v44
    v_perm_b32 v67, v50, v50, v46
    s_waitcnt lgkmcnt(5)
    ds_read_b128 v[168:171], v2 offset:27648
    v_mfma_f32_16x16x32_bf16 v[72:75], v[64:67], v[144:147], v[72:75]
    v_perm_b32 v68, v50, v50, v41
    v_perm_b32 v69, v50, v50, v43
    v_perm_b32 v70, v50, v50, v45
    v_perm_b32 v71, v50, v50, v47
    s_waitcnt lgkmcnt(5)
    ds_read_b128 v[172:175], v2 offset:28672
    v_mfma_f32_16x16x32_bf16 v[72:75], v[68:71], v[148:151], v[72:75]
    v_perm_b32 v64, v51, v51, v40
    v_perm_b32 v65, v51, v51, v42
    v_perm_b32 v66, v51, v51, v44
    v_perm_b32 v67, v51, v51, v46
    s_waitcnt lgkmcnt(5)
    ds_read_b128 v[176:179], v2 offset:29696
    v_mfma_f32_16x16x32_bf16 v[72:75], v[64:67], v[152:155], v[72:75]
    v_perm_b32 v68, v51, v51, v41
    v_perm_b32 v69, v51, v51, v43
    v_perm_b32 v70, v51, v51, v45
    v_perm_b32 v71, v51, v51, v47
    s_waitcnt lgkmcnt(5)
    ds_read_b128 v[180:183], v2 offset:30720
    v_mfma_f32_16x16x32_bf16 v[72:75], v[68:71], v[156:159], v[72:75]
    v_perm_b32 v64, v52, v52, v40
    v_perm_b32 v65, v52, v52, v42
    v_perm_b32 v66, v52, v52, v44
    v_perm_b32 v67, v52, v52, v46
    s_waitcnt lgkmcnt(5)
    ds_read_b128 v[184:187], v2 offset:31744
    v_mfma_f32_16x16x32_bf16 v[72:75], v[64:67], v[160:163], v[72:75]
    v_perm_b32 v68, v52, v52, v41
    v_perm_b32 v69, v52, v52, v43
    v_perm_b32 v70, v52, v52, v45
    v_perm_b32 v71, v52, v52, v47
    s_waitcnt lgkmcnt(5)
    ds_read_b128 v[188:191], v2 offset:32768
    v_mfma_f32_16x16x32_bf16 v[72:75], v[68:71], v[164:167], v[72:75]
    v_perm_b32 v64, v53, v53, v40
    v_perm_b32 v65, v53, v53, v42
    v_perm_b32 v66, v53, v53, v44
    v_perm_b32 v67, v53, v53, v46
    s_waitcnt lgkmcnt(5)
    ds_read_b128 v[192:195], v2 offset:33792
    v_mfma_f32_16x16x32_bf16 v[72:75], v[64:67], v[168:171], v[72:75]
    v_perm_b32 v68, v53, v53, v41
    v_perm_b32 v69, v53, v53, v43
    v_perm_b32 v70, v53, v53, v45
    v_perm_b32 v71, v53, v53, v47
    s_waitcnt lgkmcnt(5)
    ds_read_b128 v[196:199], v2 offset:34816
    v_mfma_f32_16x16x32_bf16 v[72:75], v[68:71], v[172:175], v[72:75]
    v_perm_b32 v64, v54, v54, v40
    v_perm_b32 v65, v54, v54, v42
    v_perm_b32 v66, v54, v54, v44
    v_perm_b32 v67, v54, v54, v46
    s_waitcnt lgkmcnt(5)
    ds_read_b128 v[200:203], v2 offset:35840
    v_mfma_f32_16x16x32_bf16 v[72:75], v[64:67], v[176:179], v[72:75]
    v_perm_b32 v68, v54, v54, v41
    v_perm_b32 v69, v54, v54, v43
    v_perm_b32 v70, v54, v54, v45
    v_perm_b32 v71, v54, v54, v47
    s_waitcnt lgkmcnt(5)
    ds_read_b128 v[204:207], v2 offset:36864
    v_mfma_f32_16x16x32_bf16 v[72:75], v[68:71], v[180:183], v[72:75]
L_pad1:
    s_cmp_eq_u32 s51, 1
    s_cbranch_scc1 L_pad2
    v_perm_b32 v64, v55, v55, v40
    v_perm_b32 v65, v55, v55, v42
    v_perm_b32 v66, v55, v55, v44
    v_perm_b32 v67, v55, v55, v46
    s_waitcnt lgkmcnt(5)
    ds_read_b128 v[208:211], v2 offset:37888
    v_mfma_f32_16x16x32_bf16 v[72:75], v[64:67], v[184:187], v[72:75]
    v_perm_b32 v68, v55, v55, v41
    v_perm_b32 v69, v55, v55, v43
    v_perm_b32 v70, v55, v55, v45
    v_perm_b32 v71, v55, v55, v47
    s_waitcnt lgkmcnt(5)
    ds_read_b128 v[212:215], v2 offset:38912
    v_mfma_f32_16x16x32_bf16 v[72:75], v[68:71], v[188:191], v[72:75]
    v_perm_b32 v64, v56, v56, v40
    v_perm_b32 v65, v56, v56, v42
    v_perm_b32 v66, v56, v56, v44
    v_perm_b32 v67, v56, v56, v46
    s_waitcnt lgkmcnt(5)
    ds_read_b128 v[216:219], v2 offset:39936
    v_mfma_f32_16x16x32_bf16 v[72:75], v[64:67], v[192:195], v[72:75]
    v_perm_b32 v68, v56, v56, v41
    v_perm_b32 v69, v56, v56, v43
    v_perm_b32 v70, v56, v56, v45
    v_perm_b32 v71, v56, v56, v47
    s_waitcnt lgkmcnt(5)
    ds_read_b128 v[220:223], v2 offset:40960
    v_mfma_f32_16x16x32_bf16 v[72:75], v[68:71], v[196:199], v[72:75]
    v_perm_b32 v64, v57, v57, v40
    v_perm_b32 v65, v57, v57, v42
    v_perm_b32 v66, v57, v57, v44
    v_perm_b32 v67, v57, v57, v46
    s_waitcnt lgkmcnt(5)
    ds_read_b128 v[224:227], v2 offset:41984
    v_mfma_f32_16x16x32_bf16 v[72:75], v[64:67], v[200:203], v[72:75]
    v_perm_b32 v68, v57, v57, v41
    v_perm_b32 v69, v57, v57, v43
    v_perm_b32 v70, v57, v57, v45
    v_perm_b32 v71, v57, v57, v47
    s_waitcnt lgkmcnt(5)
    ds_read_b128 v[228:231], v2 offset:43008
    v_mfma_f32_16x16x32_bf16 v[72:75], v[68:71], v[204:207], v[72:75]
    v_perm_b32 v64, v58, v58, v40
    v_perm_b32 v65, v58, v58, v42
    v_perm_b32 v66, v58, v58, v44
    v_perm_b32 v67, v58, v58, v46
    s_waitcnt lgkmcnt(5)
    ds_read_b128 v[232:235], v2 offset:44032
    v_mfma_f32_16x16x32_bf16 v[72:75], v[64:67], v[208:211], v[72:75]
    v_perm_b32 v68, v58, v58, v41
    v_perm_b32 v69, v58, v58, v43
    v_perm_b32 v70, v58, v58, v45
    v_perm_b32 v71, v58, v58, v47
    s_waitcnt lgkmcnt(5)
    ds_read_b128 v[236:239], v2 offset:45056
    v_mfma_f32_16x16x32_bf16 v[72:75], v[68:71], v[212:215], v[72:75]
    v_perm_b32 v64, v59, v59, v40
    v_perm_b32 v65, v59, v59, v42
    v_perm_b32 v66, v59, v59, v44
    v_perm_b32 v67, v59, v59, v46
    s_waitcnt lgkmcnt(5)
    ds_read_b128 v[240:243], v2 offset:46080
    v_mfma_f32_16x16x32_bf16 v[72:75], v[64:67], v[216:219], v[72:75]
    v_perm_b32 v68, v59, v59, v41
    v_perm_b32 v69, v59, v59, v43
    v_perm_b32 v70, v59, v59, v45
    v_perm_b32 v71, v59, v59, v47
    s_waitcnt lgkmcnt(5)
    ds_read_b128 v[244:247], v2 offset:47104
    v_mfma_f32_16x16x32_bf16 v[72:75], v[68:71], v[220:223], v[72:75]
    v_perm_b32 v64, v60, v60, v40
    v_perm_b32 v65, v60, v60, v42
    v_perm_b32 v66, v60, v60, v44
    v_perm_b32 v67, v60, v60, v46
    s_waitcnt lgkmcnt(5)
    ds_read_b128 v[248:251], v2 offset:48128
    v_mfma_f32_16x16x32_bf16 v[72:75], v[64:67], v[224:227], v[72:75]
    v_perm_b32 v68, v60, v60, v41
    v_perm_b32 v69, v60, v60, v43
    v_perm_b32 v70, v60, v60, v45
    v_perm_b32 v71, v60, v60, v47
    s_waitcnt lgkmcnt(5)
    ds_read_b128 v[252:255], v2 offset:49152
    v_mfma_f32_16x16x32_bf16 v[72:75], v[68:71], v[228:231], v[72:75]
    v_perm_b32 v64, v61, v61, v40
    v_perm_b32 v65, v61, v61, v42
    v_perm_b32 v66, v61, v61, v44
    v_perm_b32 v67, v61, v61, v46
    s_waitcnt lgkmcnt(5)
    s_nop 0
    v_mfma_f32_16x16x32_bf16 v[72:75], v[64:67], v[232:235], v[72:75]
    v_perm_b32 v68, v61, v61, v41
    v_perm_b32 v69, v61, v61, v43
    v_perm_b32 v70, v61, v61, v45
    v_perm_b32 v71, v61, v61, v47
    s_waitcnt lgkmcnt(4)
    s_nop 0
    v_mfma_f32_16x16x32_bf16 v[72:75], v[68:71], v[236:239], v[72:75]
    v_perm_b32 v64, v62, v62, v40
    v_perm_b32 v65, v62, v62, v42
    v_perm_b32 v66, v62, v62, v44
    v_perm_b32 v67, v62, v62, v46
    s_waitcnt lgkmcnt(3)
    s_nop 0
    v_mfma_f32_16x16x32_bf16 v[72:75], v[64:67], v[240:243], v[72:75]
    v_perm_b32 v68, v62, v62, v41
    v_perm_b32 v69, v62, v62, v43
    v_perm_b32 v70, v62, v62, v45
    v_perm_b32 v71, v62, v62, v47
    s_waitcnt lgkmcnt(2)
    s_nop 0
    v_mfma_f32_16x16x32_bf16 v[72:75], v[68:71], v[244:247], v[72:75]
    v_perm_b32 v64, v63, v63, v40
    v_perm_b32 v65, v63, v63, v42
    v_perm_b32 v66, v63, v63, v44
    v_perm_b32 v67, v63, v63, v46
    s_waitcnt lgkmcnt(1)
    s_nop 0
    v_mfma_f32_16x16x32_bf16 v[72:75], v[64:67], v[248:251], v[72:75]
    v_perm_b32 v68, v63, v63, v41
    v_perm_b32 v69, v63, v63, v43
    v_perm_b32 v70, v63, v63, v45
    v_perm_b32 v71, v63, v63, v47
    s_waitcnt lgkmcnt(0)
    s_nop 0
    v_mfma_f32_16x16x32_bf16 v[72:75], v[68:71], v[252:255], v[72:75]
    s_nop 7
    v_and_or_b32 v72, v72, v77, s37
    v_and_or_b32 v73, v73, v77, s38
    v_and_or_b32 v74, v74, v77, s39
    v_and_or_b32 v75, v75, v77, s40
    s_waitcnt vmcnt(0)
    s_mul_i32 s47, s89, 0x01010101
    v_cmp_ne_u32 vcc, s47, v79
    s_nop 0
    s_cmp_eq_u64 vcc, 0
    s_cselect_b32 s47, 1, 0
    s_cmp_eq_u32 s47, 1
    s_cbranch_scc0 L_far0
    buffer_store_dwordx4 v[72:75], v76, s[16:19], s34 offen
L_farx0:
    s_branch L_red
L_far0:
    buffer_store_dwordx4 v[72:75], v76, s[16:19], s34 offen sc1
    s_branch L_farx0
L_h0skip:
    s_waitcnt vmcnt(0)
    v_readfirstlane_b32 s36, v78
    s_nop 0
    s_add_u32 s36, s36, 0x01010101
    s_branch L_red
L_pad2:
    s_cmp_eq_u32 s51, 1
    s_cbranch_scc1 L_pad3
L_h1:
    v_mov_b32 v44, 0
    buffer_load_dword v44, v44, s[16:19], 0 offen offset:0 sc1
    s_lshl_b32 s34, s6, 4
    s_add_u32 s34, s34, s7
    s_lshl_b32 s34, s34, 11
    s_add_u32 s34, s34, 524288
    v_lshlrev_b32 v45, 5, v0
    buffer_load_dword v45, v45, s[16:19], s34 offen sc1
    s_lshl_b32 s33, s6, 10
    s_add_u32 s33, s33, 16384
    v_lshlrev_b32 v46, 4, v0
    buffer_load_dword v46, v46, s[16:19], s33 offen sc1
    s_lshl_b32 s28, s6, 13
    s_add_u32 s28, s28, 65536
    v_and_b32 v3, 3, v0
    v_lshlrev_b32 v3, 4, v3
    v_lshrrev_b32 v2, 4, v0
    v_lshl_add_u32 v2, v2, 6, v3
    v_bfe_u32 v3, v0, 2, 2
    v_lshl_add_u32 v2, v3, 11, v2
    s_waitcnt vmcnt(0)
    v_readfirstlane_b32 s36, v44
    s_nop 0
    s_add_u32 s36, s36, 0x01010101
    s_bfe_u32 s37, s36, 0x40000
    s_bfe_u32 s38, s36, 0x40008
    s_bfe_u32 s39, s36, 0x40010
    s_bfe_u32 s40, s36, 0x40018
    s_mov_b32 s50, 393216
    v_mov_b32 v4, 0
L_trA:
    ds_read_b32 v5, v4 offset:16384
    s_waitcnt lgkmcnt(0)
    v_cmp_le_u32 vcc, 10, v5
    s_cbranch_vccnz L_trAx
    s_sleep 2
    s_sub_u32 s50, s50, 1
    s_cbranch_scc0 L_trA
L_trAx:
    s_mov_b32 s50, 131072
L_poll0:
    buffer_load_dwordx4 v[8:11], v2, s[16:19], s28 offen offset:0 sc1
    buffer_load_dwordx4 v[12:15], v2, s[16:19], s28 offen offset:256 sc1
    buffer_load_dwordx4 v[16:19], v2, s[16:19], s28 offen offset:512 sc1
    buffer_load_dwordx4 v[20:23], v2, s[16:19], s28 offen offset:768 sc1
    buffer_load_dwordx4 v[24:27], v2, s[16:19], s28 offen offset:1024 sc1
    buffer_load_dwordx4 v[28:31], v2, s[16:19], s28 offen offset:1280 sc1
    buffer_load_dwordx4 v[32:35], v2, s[16:19], s28 offen offset:1536 sc1
    buffer_load_dwordx4 v[36:39], v2, s[16:19], s28 offen offset:1792 sc1
    s_waitcnt vmcnt(0)
    v_xor_b32 v8, s37, v8
    v_xor_b32 v9, s38, v9
    v_xor_b32 v10, s39, v10
    v_xor_b32 v11, s40, v11
    v_or_b32 v4, v8, v9
    v_or3_b32 v4, v10, v11, v4
    v_xor_b32 v12, s37, v12
    v_xor_b32 v13, s38, v13
    v_xor_b32 v14, s39, v14
    v_xor_b32 v15, s40, v15
    v_or3_b32 v4, v12, v13, v4
    v_or3_b32 v4, v14, v15, v4
    v_xor_b32 v16, s37, v16
    v_xor_b32 v17, s38, v17
    v_xor_b32 v18, s39, v18
    v_xor_b32 v19, s40, v19
    v_or3_b32 v4, v16, v17, v4
    v_or3_b32 v4, v18, v19, v4
    v_xor_b32 v20, s37, v20
    v_xor_b32 v21, s38, v21
    v_xor_b32 v22, s39, v22
    v_xor_b32 v23, s40, v23
    v_or3_b32 v4, v20, v21, v4
    v_or3_b32 v4, v22, v23, v4
    v_xor_b32 v24, s37, v24
    v_xor_b32 v25, s38, v25
    v_xor_b32 v26, s39, v26
    v_xor_b32 v27, s40, v27
    v_or3_b32 v4, v24, v25, v4
    v_or3_b32 v4, v26, v27, v4
    v_xor_b32 v28, s37, v28
    v_xor_b32 v29, s38, v29
    v_xor_b32 v30, s39, v30
    v_xor_b32 v31, s40, v31
    v_or3_b32 v4, v28, v29, v4
    v_or3_b32 v4, v30, v31, v4
    v_xor_b32 v32, s37, v32
    v_xor_b32 v33, s38, v33
    v_xor_b32 v34, s39, v34
    v_xor_b32 v35, s40, v35
    v_or3_b32 v4, v32, v33, v4
    v_or3_b32 v4, v34, v35, v4
    v_xor_b32 v36, s37, v36
    v_xor_b32 v37, s38, v37
    v_xor_b32 v38, s39, v38
    v_xor_b32 v39, s40, v39
    v_or3_b32 v4, v36, v37, v4
    v_or3_b32 v4, v38, v39, v4
    v_and_b32 v4, 15, v4
    v_cmp_ne_u32 vcc, 0, v4
    s_cbranch_vccz L_pollx0
    s_sleep 8
    s_sub_u32 s50, s50, 1
    s_cbranch_scc0 L_poll0
L_pollx0:
    v_add_f32 v8, v8, v16
    v_add_f32 v9, v9, v17
    v_add_f32 v10, v10, v18
    v_add_f32 v11, v11, v19
    v_add_f32 v12, v12, v20
    v_add_f32 v13, v13, v21
    v_add_f32 v14, v14, v22
    v_add_f32 v15, v15, v23
    v_add_f32 v8, v8, v24
    v_add_f32 v9, v9, v25
    v_add_f32 v10, v10, v26
    v_add_f32 v11, v11, v27
    v_add_f32 v12, v12, v28
    v_add_f32 v13, v13, v29
    v_add_f32 v14, v14, v30
    v_add_f32 v15, v15, v31
    v_add_f32 v8, v8, v32
    v_add_f32 v9, v9, v33
    v_add_f32 v10, v10, v34
    v_add_f32 v11, v11, v35
    v_add_f32 v12, v12, v36
    v_add_f32 v13, v13, v37
    v_add_f32 v14, v14, v38
    v_add_f32 v15, v15, v39
    v_cvt_pk_bf16_f32 v40, v8, v9
    v_cvt_pk_bf16_f32 v41, v10, v11
    v_cvt_pk_bf16_f32 v42, v12, v13
    v_cvt_pk_bf16_f32 v43, v14, v15
    v_lshlrev_b32 v3, 4, v0
    ds_write_b128 v3, v[40:43] offset:1024
    v_mov_b32 v4, 0
    v_mov_b32 v6, 1
    v_mov_b32 v7, s36
    s_waitcnt lgkmcnt(0)
    ds_write_b64 v4, v[6:7] offset:0
L_red:
    s_sub_u32 s29, s3, 4
    s_lshl_b32 s30, s29, 1
    v_lshrrev_b32 v1, 5, v0
    v_add_u32 v1, s30, v1
    v_lshlrev_b32 v2, 3, v1
    s_mov_b32 s50, 131072
L_mlw:
    ds_read_b64 v[8:9], v2 offset:64
    ds_read_b64 v[10:11], v2 offset:96
    ds_read_b64 v[12:13], v2 offset:128
    ds_read_b64 v[14:15], v2 offset:160
    s_waitcnt lgkmcnt(0)
    v_min_u32 v4, v9, v11
    v_min3_u32 v4, v4, v13, v15
    v_cmp_eq_u32 vcc, 0, v4
    s_cbranch_vccz L_mlx
    s_sleep 16
    s_sub_u32 s50, s50, 1
    s_cbranch_scc0 L_mlw
L_mlx:
    v_and_b32 v52, 7, v0
    v_lshlrev_b32 v52, 2, v52
    buffer_load_dword v52, v52, s[84:87], s88 offen sc1
    v_max_f32 v16, v8, v10
    v_max3_f32 v16, v16, v12, v14
    v_sub_f32 v20, v8, v16
    v_sub_f32 v21, v10, v16
    v_sub_f32 v22, v12, v16
    v_sub_f32 v23, v14, v16
    v_mul_f32 v20, 0x3fb8aa3b, v20
    v_mul_f32 v21, 0x3fb8aa3b, v21
    v_mul_f32 v22, 0x3fb8aa3b, v22
    v_mul_f32 v23, 0x3fb8aa3b, v23
    v_exp_f32 v20, v20
    v_exp_f32 v21, v21
    v_exp_f32 v22, v22
    v_exp_f32 v23, v23
    v_mul_f32 v17, v20, v9
    v_fmac_f32 v17, v21, v11
    v_fmac_f32 v17, v22, v13
    v_fmac_f32 v17, v23, v15
    v_mov_b32 v18, s36
    v_not_b32 v19, s36
    s_lshl_b32 s33, s6, 10
    s_add_u32 s33, s33, 16384
    s_lshl_b32 s35, s7, 4
    s_add_u32 s32, s33, s35
    v_lshlrev_b32 v3, 8, v1
    v_and_b32 v6, 15, v0
    v_lshl_add_u32 v6, v6, 4, v3
    s_lshl_b32 s34, s6, 4
    s_add_u32 s34, s34, s7
    s_lshl_b32 s34, s34, 11
    s_add_u32 s34, s34, 524288
    v_lshlrev_b32 v26, 4, v0
    s_lshl_b32 s35, s29, 10
    v_add_u32 v26, s35, v26
    s_waitcnt vmcnt(0)
    s_mul_i32 s47, s89, 0x01010101
    v_cmp_ne_u32 vcc, s47, v52
    s_nop 0
    s_cmp_eq_u64 vcc, 0
    s_cselect_b32 s47, 1, 0
    s_mov_b32 exec_lo, 1
    s_mov_b32 exec_hi, 1
    s_cmp_eq_u32 s47, 1
    s_cbranch_scc0 L_far1
    buffer_store_dwordx4 v[16:19], v3, s[16:19], s32 offen
L_farx1:
    s_mov_b64 exec, -1
L_pad3:
    s_cmp_eq_u32 s51, 1
    s_cbranch_scc1 L_pad4
    s_mov_b32 s50, 87381
    v_mov_b32 v4, 0
L_trC:
    ds_read_b32 v5, v4 offset:16384
    s_waitcnt lgkmcnt(0)
    v_cmp_le_u32 vcc, 90, v5
    s_cbranch_vccnz L_trCx
    s_sleep 16
    s_sub_u32 s50, s50, 1
    s_cbranch_scc0 L_trC
L_trCx:
    s_mov_b32 s50, 65536
L_poll1:
    buffer_load_dwordx4 v[8:11], v6, s[16:19], s33 offen sc1
    s_waitcnt vmcnt(0)
    v_xor_b32 v10, s36, v10
    v_xnor_b32 v11, s36, v11
    v_or_b32 v10, v10, v11
    v_cmp_ne_u32 vcc, 0, v10
    s_cbranch_vccz L_pollx1
    s_sleep 16
    s_sub_u32 s50, s50, 1
    s_cbranch_scc0 L_poll1
L_pollx1:
    v_mov_b32 v12, v8
    s_nop 1
    v_max_f32_dpp v12, v12, v12 row_ror:1 row_mask:0xf bank_mask:0xf
    s_nop 1
    v_max_f32_dpp v12, v12, v12 row_ror:2 row_mask:0xf bank_mask:0xf
    s_nop 1
    v_max_f32_dpp v12, v12, v12 row_ror:4 row_mask:0xf bank_mask:0xf
    s_nop 1
    v_max_f32_dpp v12, v12, v12 row_ror:8 row_mask:0xf bank_mask:0xf
    v_sub_f32 v8, v8, v12
    v_sub_f32 v16, v16, v12
    v_mul_f32 v8, 0x3fb8aa3b, v8
    v_mul_f32 v16, 0x3fb8aa3b, v16
    v_exp_f32 v8, v8
    v_exp_f32 v16, v16
    v_mul_f32 v8, v8, v9
    s_nop 1
    v_add_f32_dpp v8, v8, v8 row_ror:1 row_mask:0xf bank_mask:0xf
    s_nop 1
    v_add_f32_dpp v8, v8, v8 row_ror:2 row_mask:0xf bank_mask:0xf
    s_nop 1
    v_add_f32_dpp v8, v8, v8 row_ror:4 row_mask:0xf bank_mask:0xf
    s_nop 1
    v_add_f32_dpp v8, v8, v8 row_ror:8 row_mask:0xf bank_mask:0xf
    v_rcp_f32 v8, v8
    s_nop 0
    v_mul_f32 v16, v16, v8
    v_mul_f32 v20, v20, v16
    v_mul_f32 v21, v21, v16
    v_mul_f32 v22, v22, v16
    v_mul_f32 v23, v23, v16
    s_bfe_u32 s37, s36, 0x80000
    s_bfe_u32 s38, s36, 0x80008
    s_bfe_u32 s39, s36, 0x80010
    s_bfe_u32 s40, s36, 0x80018
    v_mov_b32 v24, 0xffffff00
    s_setprio 3
    s_cmp_eq_u32 s47, 1
    s_barrier
    ds_read_b128 v[32:35], v26 offset:4096
    ds_read_b128 v[36:39], v26 offset:6144
    ds_read_b128 v[40:43], v26 offset:8192
    ds_read_b128 v[44:47], v26 offset:10240
    s_waitcnt lgkmcnt(3)
    v_pk_mul_f32 v[28:29], v[20:21], v[32:33] op_sel:[0,0] op_sel_hi:[0,1]
    v_pk_mul_f32 v[30:31], v[20:21], v[34:35] op_sel:[0,0] op_sel_hi:[0,1]
    s_waitcnt lgkmcnt(2)
    v_pk_fma_f32 v[28:29], v[20:21], v[36:37], v[28:29] op_sel:[1,0,0] op_sel_hi:[1,1,1]
    v_pk_fma_f32 v[30:31], v[20:21], v[38:39], v[30:31] op_sel:[1,0,0] op_sel_hi:[1,1,1]
    s_waitcnt lgkmcnt(1)
    v_pk_fma_f32 v[28:29], v[22:23], v[40:41], v[28:29] op_sel:[0,0,0] op_sel_hi:[0,1,1]
    v_pk_fma_f32 v[30:31], v[22:23], v[42:43], v[30:31] op_sel:[0,0,0] op_sel_hi:[0,1,1]
    s_waitcnt lgkmcnt(0)
    v_pk_fma_f32 v[28:29], v[22:23], v[44:45], v[28:29] op_sel:[1,0,0] op_sel_hi:[1,1,1]
    v_pk_fma_f32 v[30:31], v[22:23], v[46:47], v[30:31] op_sel:[1,0,0] op_sel_hi:[1,1,1]
    v_and_or_b32 v28, v28, v24, s37
    v_and_or_b32 v29, v29, v24, s38
    v_and_or_b32 v30, v30, v24, s39
    v_and_or_b32 v31, v31, v24, s40
    s_cbranch_scc0 L_far2
    buffer_store_dwordx4 v[28:31], v26, s[16:19], s34 offen
L_farx2:
    s_endpgm
L_far1:
    buffer_store_dwordx4 v[16:19], v3, s[16:19], s32 offen sc1
    s_branch L_farx1
L_far2:
    buffer_store_dwordx4 v[28:31], v26, s[16:19], s34 offen sc1
    s_branch L_farx2
L_h3:
    s_mov_b32 s20, s58
    s_mov_b32 s21, s59
    s_mov_b32 s22, 2048
    v_mov_b32 v50, 0
    buffer_load_dword v50, v50, s[16:19], 0 offen offset:0 sc1
    v_and_b32 v1, 3, v0
    v_lshlrev_b32 v2, 2, v1
    v_lshlrev_b32 v1, 8, v1
    v_and_b32 v3, 31, v0
    v_lshlrev_b32 v3, 2, v3
    s_lshl_b32 s28, s89, 8
    s_add_u32 s28, s28, 4096
    s_lshr_b32 s29, s2, 3
    s_lshl_b32 s29, s29, 2
    v_mov_b32 v8, s29
    s_mov_b32 s49, 396
    s_bitcmp1_b32 s89, 0
    s_cselect_b32 s49, 500, s49
    s_waitcnt vmcnt(0)
    v_readfirstlane_b32 s36, v50
    s_nop 0
    s_add_u32 s36, s36, 0x01010101
    s_and_b32 s33, s36, 0xfffffc00
    s_mov_b32 s50, 262144
L_cl:
    ds_read_b32 v10, v1 offset:16384
    s_waitcnt lgkmcnt(0)
    v_add_u32_dpp v11, v10, v10 quad_perm:[1,0,3,2] row_mask:0xf bank_mask:0xf
    s_nop 1
    v_add_u32_dpp v11, v11, v11 quad_perm:[2,3,0,1] row_mask:0xf bank_mask:0xf
    v_or_b32 v12, s33, v11
    v_readfirstlane_b32 s31, v11
    s_mov_b64 exec, 1
    buffer_store_dword v12, v8, s[16:19], s28 offen
    s_mov_b64 exec, -1
    s_cmp_ge_u32 s31, 508
    s_cbranch_scc1 L_cx
    buffer_load_dword v13, v3, s[16:19], s28 offen sc1
    s_waitcnt vmcnt(0)
    v_xor_b32 v13, s33, v13
    v_cmp_gt_u32 vcc, 0x400, v13
    s_nop 1
    v_cndmask_b32 v13, v11, v13, vcc
    s_nop 1
    v_add_u32_dpp v13, v13, v13 row_ror:1 row_mask:0xf bank_mask:0xf
    s_nop 1
    v_add_u32_dpp v13, v13, v13 row_ror:2 row_mask:0xf bank_mask:0xf
    s_nop 1
    v_add_u32_dpp v13, v13, v13 row_ror:4 row_mask:0xf bank_mask:0xf
    s_nop 1
    v_add_u32_dpp v13, v13, v13 row_ror:8 row_mask:0xf bank_mask:0xf
    v_mov_b32 v14, v13
    s_nop 1
    v_permlane16_swap_b32 v14, v13
    v_add_u32 v13, v13, v14
    v_lshlrev_b32 v14, 7, v10
    v_sub_u32 v13, v13, v14
    v_add_u32 v13, s49, v13
    v_ashrrev_i32 v13, 7, v13
    ds_write_b32 v2, v13 offset:256
    s_sub_u32 s50, s50, 1
    s_cbranch_scc0 L_cl
L_cx:
    s_and_b32 s30, s42, 3
    s_cmp_lg_u32 s30, 0
    s_cbranch_scc1 L_fin
    s_lshr_b32 s30, s2, 7
    s_lshl_b32 s30, s30, 3
    s_or_b32 s30, s30, s41
    s_and_b32 s29, s2, 4
    s_or_b32 s30, s30, s29
    s_and_b32 s41, s2, 3
    s_lshl_b32 s44, s41, 16
    s_lshl_b32 s31, s30, 6
    s_add_u32 s44, s44, s31
    s_add_u32 s44, s44, 1048576
    s_add_u32 s45, s44, 16384
    s_add_u32 s46, s44, 32768
    s_add_u32 s47, s44, 49152
    v_and_b32 v44, 7, v0
    s_and_b32 s29, s2, 7
    v_xor_b32 v45, 1, v44
    v_cmp_eq_u32 vcc, s29, v44
    s_nop 1
    v_cndmask_b32 v44, v44, v45, vcc
    v_lshlrev_b32 v44, 8, v44
    s_mov_b32 s43, 8192
    v_lshrrev_b32 v1, 2, v0
    v_lshlrev_b32 v1, 10, v1
    v_and_b32 v2, 3, v0
    v_lshlrev_b32 v2, 4, v2
    v_add_u32 v1, v1, v2
    s_bfe_u32 s32, s30, 0x10002
    s_lshl_b32 s32, s32, 10
    s_lshl_b32 s33, s41, 8
    s_add_u32 s32, s32, s33
    s_and_b32 s33, s30, 3
    s_lshl_b32 s33, s33, 6
    s_add_u32 s32, s32, s33
    s_lshr_b32 s33, s30, 3
    s_lshl_b32 s33, s33, 3
    s_add_u32 s32, s32, s33
    v_lshrrev_b32 v3, 4, v0
    v_lshl_add_u32 v2, v3, 1, v2
    buffer_load_ushort v30, v2, s[24:27], s32 offen
    s_bfe_u32 s37, s36, 0x80000
    s_bfe_u32 s38, s36, 0x80008
    s_bfe_u32 s39, s36, 0x80010
    s_bfe_u32 s40, s36, 0x80018
    v_mov_b32 v32, s36
    v_mov_b32 v34, 0
    s_mov_b32 s48, 262144
    s_mov_b32 s50, 262144
L_pad4:
    s_cmp_eq_u32 s51, 1
    s_cbranch_scc1 L_pad5
    s_setprio 3
    s_barrier
    s_barrier
    buffer_load_dword v48, v44, s[16:19], s43 offen sc1
    buffer_load_dword v49, v44, s[16:19], s43 offen sc1
    buffer_load_dword v50, v44, s[16:19], s43 offen sc1
    buffer_load_dword v51, v44, s[16:19], s43 offen sc1
    buffer_load_dword v52, v44, s[16:19], s43 offen sc1
L_flw:
    buffer_load_dword v53, v44, s[16:19], s43 offen sc1
    s_waitcnt vmcnt(5)
    v_cmp_ne_u32 vcc, s36, v48
    s_cbranch_vccz L_flx
    buffer_load_dword v48, v44, s[16:19], s43 offen sc1
    s_waitcnt vmcnt(5)
    v_cmp_ne_u32 vcc, s36, v49
    s_cbranch_vccz L_flx
    buffer_load_dword v49, v44, s[16:19], s43 offen sc1
    s_waitcnt vmcnt(5)
    v_cmp_ne_u32 vcc, s36, v50
    s_cbranch_vccz L_flx
    buffer_load_dword v50, v44, s[16:19], s43 offen sc1
    s_waitcnt vmcnt(5)
    v_cmp_ne_u32 vcc, s36, v51
    s_cbranch_vccz L_flx
    buffer_load_dword v51, v44, s[16:19], s43 offen sc1
    s_waitcnt vmcnt(5)
    v_cmp_ne_u32 vcc, s36, v52
    s_cbranch_vccz L_flx
    buffer_load_dword v52, v44, s[16:19], s43 offen sc1
    s_waitcnt vmcnt(5)
    v_cmp_ne_u32 vcc, s36, v53
    s_cbranch_vccz L_flx
    s_sub_u32 s50, s50, 1
    s_cbranch_scc0 L_flw
L_flx:
L_poll2:
    buffer_load_dwordx4 v[64:67], v1, s[16:19], s44 offen sc1
    buffer_load_dwordx4 v[68:71], v1, s[16:19], s45 offen sc1
    buffer_load_dwordx4 v[72:75], v1, s[16:19], s46 offen sc1
    buffer_load_dwordx4 v[76:79], v1, s[16:19], s47 offen sc1
    s_waitcnt vmcnt(3)
    v_xor_b32 v64, s37, v64
    v_xor_b32 v65, s38, v65
    v_xor_b32 v66, s39, v66
    v_xor_b32 v67, s40, v67
    v_or_b32 v4, v64, v65
    v_or3_b32 v4, v66, v67, v4
    s_waitcnt vmcnt(2)
    v_xor_b32 v68, s37, v68
    v_xor_b32 v69, s38, v69
    v_xor_b32 v70, s39, v70
    v_xor_b32 v71, s40, v71
    v_or3_b32 v4, v68, v69, v4
    v_or3_b32 v4, v70, v71, v4
    v_pk_add_f32 v[8:9], v[64:65], v[68:69]
    v_pk_add_f32 v[10:11], v[66:67], v[70:71]
    s_waitcnt vmcnt(1)
    v_xor_b32 v72, s37, v72
    v_xor_b32 v73, s38, v73
    v_xor_b32 v74, s39, v74
    v_xor_b32 v75, s40, v75
    v_or3_b32 v4, v72, v73, v4
    v_or3_b32 v4, v74, v75, v4
    v_pk_add_f32 v[8:9], v[8:9], v[72:73]
    v_pk_add_f32 v[10:11], v[10:11], v[74:75]
    s_waitcnt vmcnt(0)
    v_xor_b32 v76, s37, v76
    v_xor_b32 v77, s38, v77
    v_xor_b32 v78, s39, v78
    v_xor_b32 v79, s40, v79
    v_or3_b32 v4, v76, v77, v4
    v_or3_b32 v4, v78, v79, v4
    v_cmp_ne_u32_sdwa vcc, v4, 0 src0_sel:BYTE_0 src1_sel:DWORD
    v_pk_add_f32 v[8:9], v[8:9], v[76:77]
    v_pk_add_f32 v[10:11], v[10:11], v[78:79]
    s_cbranch_vccnz L_retry2
L_pollx2:
    s_mov_b64 exec, -1
    v_permlane32_swap_b32 v8, v10
    v_permlane32_swap_b32 v9, v11
    v_add_f32 v8, v8, v10
    v_add_f32 v9, v9, v11
    v_lshlrev_b32 v30, 16, v30
    s_nop 0
    v_permlane16_swap_b32 v8, v9
    v_add_f32 v8, v8, v9
    s_nop 1
    v_add_f32_dpp v8, v8, v8 row_ror:4 row_mask:0xf bank_mask:0xf
    s_nop 1
    v_add_f32_dpp v8, v8, v8 row_ror:8 row_mask:0xf bank_mask:0xf
    s_mov_b32 exec_lo, 0x000f000f
    s_mov_b32 exec_hi, 0x000f000f
    v_add_f32 v8, v8, v30
    v_cvt_pk_bf16_f32 v8, v8, v8
    buffer_store_short v8, v2, s[20:23], s32 offen
    s_cmp_lg_u32 s2, 0
    s_cbranch_scc1 L_fin
    s_mov_b64 exec, 1
    buffer_store_dword v32, v34, s[16:19], 0 offen offset:0 sc1
L_fin:
    s_endpgm
L_retry2:
    s_wqm_b64 exec, vcc
    s_sub_u32 s48, s48, 1
    s_cbranch_scc0 L_poll2
    s_branch L_pollx2
L_h2:
    s_getpc_b64 s[4:5]
L_pc:
    s_sub_u32 s4, s4, L_pc-parallel_sum__gqa_block_cached__geglu_ffn__decode_kernel
    s_subb_u32 s5, s5, 0
    s_bfe_u32 s29, s2, 0x40003
    s_mul_i32 s29, s29, 2304
    v_lshlrev_b32 v60, 7, v0
    v_add_u32 v60, s29, v60
    v_min_u32 v60, L_end-parallel_sum__gqa_block_cached__geglu_ffn__decode_kernel, v60
    s_mov_b64 exec, 0x3ffff
    global_load_dword v60, v60, s[4:5]
    s_mov_b64 exec, -1
    s_waitcnt vmcnt(0)
    s_mov_b32 s51, 1
    s_branch L_pad0
L_padret:
    s_mov_b32 s51, 0
    v_mov_b32 v36, 0
    v_mov_b32 v37, 0
    v_mov_b32 v38, 0
    v_mov_b32 v39, 0
    s_cmp_ge_u32 s42, 56
    s_cbranch_scc1 L_h2w
    v_mov_b32 v50, 0
    buffer_load_dword v50, v50, s[16:19], 0 offen offset:0 sc1
    v_and_b32 v4, 1, v0
    v_cmp_eq_u32 vcc, 1, v4
    v_mov_b32 v5, 0x0c0c0100
    v_mov_b32 v6, 0x01000c0c
    v_cndmask_b32 v5, v5, v6, vcc
    v_mov_b32 v6, 0x0c0c0302
    v_mov_b32 v7, 0x03020c0c
    v_cndmask_b32 v6, v6, v7, vcc
    v_bfe_u32 v4, v0, 3, 1
    v_bfe_u32 v7, v0, 1, 1
    v_lshl_add_u32 v4, v4, 1, v7
    v_mov_b32 v7, 0x0c0c0c0c
    v_cmp_eq_u32 vcc, 0, v4
    s_nop 1
    v_cndmask_b32 v40, v7, v5, vcc
    v_cndmask_b32 v41, v7, v6, vcc
    v_cmp_eq_u32 vcc, 1, v4
    s_nop 1
    v_cndmask_b32 v42, v7, v5, vcc
    v_cndmask_b32 v43, v7, v6, vcc
    v_cmp_eq_u32 vcc, 2, v4
    s_nop 1
    v_cndmask_b32 v44, v7, v5, vcc
    v_cndmask_b32 v45, v7, v6, vcc
    v_cmp_eq_u32 vcc, 3, v4
    s_nop 1
    v_cndmask_b32 v46, v7, v5, vcc
    v_cndmask_b32 v47, v7, v6, vcc
    s_lshl_b32 s28, s42, 11
    s_add_u32 s28, s28, 196608
    v_and_b32 v1, 15, v0
    v_lshrrev_b32 v3, 4, v0
    v_lshlrev_b32 v1, 7, v1
    v_lshl_add_u32 v1, v3, 4, v1
    s_waitcnt vmcnt(0)
    v_readfirstlane_b32 s36, v50
    s_nop 0
    s_add_u32 s36, s36, 0x01010101
    s_bfe_u32 s37, s36, 0x40000
    s_bfe_u32 s38, s36, 0x40008
    s_bfe_u32 s39, s36, 0x40010
    s_bfe_u32 s40, s36, 0x40018
    s_mov_b32 s50, 87381
    v_mov_b32 v4, 0
L_trB:
    ds_read_b32 v5, v4 offset:16384
    s_waitcnt lgkmcnt(0)
    v_cmp_le_u32 vcc, 50, v5
    s_cbranch_vccnz L_trBx
    s_sleep 16
    s_sub_u32 s50, s50, 1
    s_cbranch_scc0 L_trB
L_trBx:
    s_mov_b32 s50, 524288
    v_and_b32 v4, 3, v0
    v_lshlrev_b32 v4, 8, v4
L_ww2:
    ds_read_b32 v5, v4 offset:16384
    s_waitcnt lgkmcnt(0)
    v_cmp_eq_u32 vcc, 0, v5
    s_cbranch_vccz L_ww2x
    s_sleep 1
    s_sub_u32 s50, s50, 1
    s_cbranch_scc0 L_ww2
L_ww2x:
    v_lshlrev_b32 v2, 4, v0
    ds_read_b128 v[64:67], v2 offset:50176
    ds_read_b128 v[68:71], v2 offset:51200
    ds_read_b128 v[72:75], v2 offset:52224
    ds_read_b128 v[76:79], v2 offset:53248
    ds_read_b128 v[80:83], v2 offset:54272
    ds_read_b128 v[84:87], v2 offset:55296
    ds_read_b128 v[88:91], v2 offset:56320
    ds_read_b128 v[92:95], v2 offset:57344
    s_waitcnt lgkmcnt(0)
    s_mov_b32 s50, 32768
L_poll3:
    buffer_load_dwordx4 v[8:11], v1, s[16:19], s28 offen sc1
    buffer_load_dwordx4 v[12:15], v1, s[16:19], s28 offen offset:64 sc1
    s_waitcnt vmcnt(0)
    v_xor_b32 v8, s37, v8
    v_xor_b32 v9, s38, v9
    v_xor_b32 v10, s39, v10
    v_xor_b32 v11, s40, v11
    v_or_b32 v4, v8, v9
    v_or3_b32 v4, v10, v11, v4
    v_xor_b32 v12, s37, v12
    v_xor_b32 v13, s38, v13
    v_xor_b32 v14, s39, v14
    v_xor_b32 v15, s40, v15
    v_or3_b32 v4, v12, v13, v4
    v_or3_b32 v4, v14, v15, v4
    v_and_b32 v4, 15, v4
    v_cmp_ne_u32 vcc, 0, v4
    s_cbranch_vccz L_pollx3
    s_sleep 32
    s_sub_u32 s50, s50, 1
    s_cbranch_scc0 L_poll3
L_pollx3:
L_pad5:
    s_cmp_eq_u32 s51, 1
    s_cbranch_scc1 L_pad6
    v_add_f32_dpp v8, v8, v8 quad_perm:[1,0,3,2] row_mask:0xf bank_mask:0xf
    v_add_f32_dpp v9, v9, v9 quad_perm:[1,0,3,2] row_mask:0xf bank_mask:0xf
    v_add_f32_dpp v10, v10, v10 quad_perm:[1,0,3,2] row_mask:0xf bank_mask:0xf
    v_add_f32_dpp v11, v11, v11 quad_perm:[1,0,3,2] row_mask:0xf bank_mask:0xf
    v_add_f32_dpp v12, v12, v12 quad_perm:[1,0,3,2] row_mask:0xf bank_mask:0xf
    v_add_f32_dpp v13, v13, v13 quad_perm:[1,0,3,2] row_mask:0xf bank_mask:0xf
    v_add_f32_dpp v14, v14, v14 quad_perm:[1,0,3,2] row_mask:0xf bank_mask:0xf
    v_add_f32_dpp v15, v15, v15 quad_perm:[1,0,3,2] row_mask:0xf bank_mask:0xf
    v_add_f32_dpp v8, v8, v8 quad_perm:[2,3,0,1] row_mask:0xf bank_mask:0xf
    v_add_f32_dpp v9, v9, v9 quad_perm:[2,3,0,1] row_mask:0xf bank_mask:0xf
    v_add_f32_dpp v10, v10, v10 quad_perm:[2,3,0,1] row_mask:0xf bank_mask:0xf
    v_add_f32_dpp v11, v11, v11 quad_perm:[2,3,0,1] row_mask:0xf bank_mask:0xf
    v_add_f32_dpp v12, v12, v12 quad_perm:[2,3,0,1] row_mask:0xf bank_mask:0xf
    v_add_f32_dpp v13, v13, v13 quad_perm:[2,3,0,1] row_mask:0xf bank_mask:0xf
    v_add_f32_dpp v14, v14, v14 quad_perm:[2,3,0,1] row_mask:0xf bank_mask:0xf
    v_add_f32_dpp v15, v15, v15 quad_perm:[2,3,0,1] row_mask:0xf bank_mask:0xf
    v_cvt_pk_bf16_f32 v8, v8, v8
    v_and_b32 v8, 0xffff0000, v8
    v_cvt_pk_bf16_f32 v9, v9, v9
    v_and_b32 v9, 0xffff0000, v9
    v_cvt_pk_bf16_f32 v10, v10, v10
    v_and_b32 v10, 0xffff0000, v10
    v_cvt_pk_bf16_f32 v11, v11, v11
    v_and_b32 v11, 0xffff0000, v11
    v_cvt_pk_bf16_f32 v12, v12, v12
    v_and_b32 v12, 0xffff0000, v12
    v_cvt_pk_bf16_f32 v13, v13, v13
    v_and_b32 v13, 0xffff0000, v13
    v_cvt_pk_bf16_f32 v14, v14, v14
    v_and_b32 v14, 0xffff0000, v14
    v_cvt_pk_bf16_f32 v15, v15, v15
    v_and_b32 v15, 0xffff0000, v15
    s_mov_b32 s33, 0x3d372713
    v_mul_f32 v16, v8, v8
    v_mul_f32 v17, v9, v9
    v_mul_f32 v18, v10, v10
    v_mul_f32 v19, v11, v11
    v_mul_f32 v20, v12, v12
    v_mul_f32 v21, v13, v13
    v_mul_f32 v22, v14, v14
    v_mul_f32 v23, v15, v15
    v_mul_f32 v16, v16, v8
    v_mul_f32 v17, v17, v9
    v_mul_f32 v18, v18, v10
    v_mul_f32 v19, v19, v11
    v_mul_f32 v20, v20, v12
    v_mul_f32 v21, v21, v13
    v_mul_f32 v22, v22, v14
    v_mul_f32 v23, v23, v15
    v_fma_f32 v16, v16, s33, v8
    v_fma_f32 v17, v17, s33, v9
    v_fma_f32 v18, v18, s33, v10
    v_fma_f32 v19, v19, s33, v11
    v_fma_f32 v20, v20, s33, v12
    v_fma_f32 v21, v21, s33, v13
    v_fma_f32 v22, v22, s33, v14
    v_fma_f32 v23, v23, s33, v15
    v_mul_f32 v16, 0xc0135761, v16
    v_mul_f32 v17, 0xc0135761, v17
    v_mul_f32 v18, 0xc0135761, v18
    v_mul_f32 v19, 0xc0135761, v19
    v_mul_f32 v20, 0xc0135761, v20
    v_mul_f32 v21, 0xc0135761, v21
    v_mul_f32 v22, 0xc0135761, v22
    v_mul_f32 v23, 0xc0135761, v23
    v_exp_f32 v16, v16
    v_exp_f32 v17, v17
    v_exp_f32 v18, v18
    v_exp_f32 v19, v19
    v_exp_f32 v20, v20
    v_exp_f32 v21, v21
    v_exp_f32 v22, v22
    v_exp_f32 v23, v23
    v_add_f32 v16, 1.0, v16
    v_add_f32 v17, 1.0, v17
    v_add_f32 v18, 1.0, v18
    v_add_f32 v19, 1.0, v19
    v_add_f32 v20, 1.0, v20
    v_add_f32 v21, 1.0, v21
    v_add_f32 v22, 1.0, v22
    v_add_f32 v23, 1.0, v23
    v_rcp_f32 v16, v16
    v_rcp_f32 v17, v17
    v_rcp_f32 v18, v18
    v_rcp_f32 v19, v19
    v_rcp_f32 v20, v20
    v_rcp_f32 v21, v21
    v_rcp_f32 v22, v22
    v_rcp_f32 v23, v23
    v_mul_f32 v16, v16, v8
    v_mul_f32 v17, v17, v9
    v_mul_f32 v18, v18, v10
    v_mul_f32 v19, v19, v11
    v_mul_f32 v20, v20, v12
    v_mul_f32 v21, v21, v13
    v_mul_f32 v22, v22, v14
    v_mul_f32 v23, v23, v15
    v_cvt_pk_bf16_f32 v16, v16, v16
    v_and_b32 v16, 0xffff0000, v16
    v_cvt_pk_bf16_f32 v17, v17, v17
    v_and_b32 v17, 0xffff0000, v17
    v_cvt_pk_bf16_f32 v18, v18, v18
    v_and_b32 v18, 0xffff0000, v18
    v_cvt_pk_bf16_f32 v19, v19, v19
    v_and_b32 v19, 0xffff0000, v19
    v_cvt_pk_bf16_f32 v20, v20, v20
    v_and_b32 v20, 0xffff0000, v20
    v_cvt_pk_bf16_f32 v21, v21, v21
    v_and_b32 v21, 0xffff0000, v21
    v_cvt_pk_bf16_f32 v22, v22, v22
    v_and_b32 v22, 0xffff0000, v22
    v_cvt_pk_bf16_f32 v23, v23, v23
    v_and_b32 v23, 0xffff0000, v23
    s_mov_b32 vcc_lo, 0xff00ff00
    s_mov_b32 vcc_hi, 0xff00ff00
    v_cndmask_b32 v8, v16, v8, vcc
    v_cndmask_b32 v9, v17, v9, vcc
    v_cndmask_b32 v10, v18, v10, vcc
    v_cndmask_b32 v11, v19, v11, vcc
    v_cndmask_b32 v12, v20, v12, vcc
    v_cndmask_b32 v13, v21, v13, vcc
    v_cndmask_b32 v14, v22, v14, vcc
    v_cndmask_b32 v15, v23, v15, vcc
L_pad6:
    s_cmp_eq_u32 s51, 1
    s_cbranch_scc1 L_pad7
    v_mul_f32_dpp v16, v8, v8 row_ror:8 row_mask:0xf bank_mask:0xf
    v_mul_f32_dpp v17, v9, v9 row_ror:8 row_mask:0xf bank_mask:0xf
    v_mul_f32_dpp v18, v10, v10 row_ror:8 row_mask:0xf bank_mask:0xf
    v_mul_f32_dpp v19, v11, v11 row_ror:8 row_mask:0xf bank_mask:0xf
    v_mul_f32_dpp v20, v12, v12 row_ror:8 row_mask:0xf bank_mask:0xf
    v_mul_f32_dpp v21, v13, v13 row_ror:8 row_mask:0xf bank_mask:0xf
    v_mul_f32_dpp v22, v14, v14 row_ror:8 row_mask:0xf bank_mask:0xf
    v_mul_f32_dpp v23, v15, v15 row_ror:8 row_mask:0xf bank_mask:0xf
    v_cvt_pk_bf16_f32 v24, v16, v17
    v_cvt_pk_bf16_f32 v25, v18, v19
    v_cvt_pk_bf16_f32 v26, v20, v21
    v_cvt_pk_bf16_f32 v27, v22, v23
    v_perm_b32 v28, v24, v24, v40
    v_perm_b32 v29, v24, v24, v42
    v_perm_b32 v30, v24, v24, v44
    v_perm_b32 v31, v24, v24, v46
    s_nop 1
    v_mfma_f32_16x16x32_bf16 v[36:39], v[28:31], v[64:67], v[36:39]
    v_perm_b32 v32, v24, v24, v41
    v_perm_b32 v33, v24, v24, v43
    v_perm_b32 v34, v24, v24, v45
    v_perm_b32 v35, v24, v24, v47
    s_nop 1
    v_mfma_f32_16x16x32_bf16 v[36:39], v[32:35], v[68:71], v[36:39]
    v_perm_b32 v28, v25, v25, v40
    v_perm_b32 v29, v25, v25, v42
    v_perm_b32 v30, v25, v25, v44
    v_perm_b32 v31, v25, v25, v46
    s_nop 1
    v_mfma_f32_16x16x32_bf16 v[36:39], v[28:31], v[72:75], v[36:39]
    v_perm_b32 v32, v25, v25, v41
    v_perm_b32 v33, v25, v25, v43
    v_perm_b32 v34, v25, v25, v45
    v_perm_b32 v35, v25, v25, v47
    s_nop 1
    v_mfma_f32_16x16x32_bf16 v[36:39], v[32:35], v[76:79], v[36:39]
    v_perm_b32 v28, v26, v26, v40
    v_perm_b32 v29, v26, v26, v42
    v_perm_b32 v30, v26, v26, v44
    v_perm_b32 v31, v26, v26, v46
    s_nop 1
    v_mfma_f32_16x16x32_bf16 v[36:39], v[28:31], v[80:83], v[36:39]
    v_perm_b32 v32, v26, v26, v41
    v_perm_b32 v33, v26, v26, v43
    v_perm_b32 v34, v26, v26, v45
    v_perm_b32 v35, v26, v26, v47
    s_nop 1
    v_mfma_f32_16x16x32_bf16 v[36:39], v[32:35], v[84:87], v[36:39]
    v_perm_b32 v28, v27, v27, v40
    v_perm_b32 v29, v27, v27, v42
    v_perm_b32 v30, v27, v27, v44
    v_perm_b32 v31, v27, v27, v46
    s_nop 1
    v_mfma_f32_16x16x32_bf16 v[36:39], v[28:31], v[88:91], v[36:39]
    v_perm_b32 v32, v27, v27, v41
    v_perm_b32 v33, v27, v27, v43
    v_perm_b32 v34, v27, v27, v45
    v_perm_b32 v35, v27, v27, v47
    s_nop 1
    v_mfma_f32_16x16x32_bf16 v[36:39], v[32:35], v[92:95], v[36:39]
L_h2w:
    v_lshlrev_b32 v3, 4, v0
    s_nop 6
    ds_write_b128 v3, v[36:39] offset:12288
    s_waitcnt lgkmcnt(0)
    s_endpgm
L_h2pre:
    s_branch L_h2
L_stream:
    s_waitcnt lgkmcnt(0)
    s_mov_b32 s12, s90
    s_mov_b32 s13, s91
    s_mov_b32 s14, 0x8000000
    s_mov_b32 s20, s92
    s_mov_b32 s21, s93
    s_mov_b32 s22, 0x400000
    v_lshlrev_b32 v2, 4, v0
    s_mov_b32 s44, 0x22222222
    s_mov_b32 s45, 0x22222222
    s_mov_b32 s46, 0x44444444
    s_mov_b32 s47, 0x44444444
    s_mov_b32 s48, 0x88888888
    s_mov_b32 s49, 0x88888888
    v_mov_b32 v3, 0xffff0000
    v_mov_b32 v4, 0xffff
    v_cndmask_b32 v4, v4, v3, s[44:45]
    v_cndmask_b32 v5, 0, v4, s[46:47]
    v_cndmask_b32 v5, v5, v3, s[48:49]
    v_cndmask_b32 v4, v4, 0, s[46:47]
    v_cndmask_b32 v4, v4, 0, s[48:49]
    v_mov_b32 v6, 0xff800000
    v_mov_b32 v36, 0
    v_mov_b32 v37, 0
    v_mov_b32 v38, 0
    v_mov_b32 v39, 0
    v_mov_b32 v40, 0
    v_mov_b32 v41, 0
    v_mov_b32 v42, 0
    v_mov_b32 v43, 0
    s_lshl_b32 s29, s3, 2
    v_mov_b32 v77, s29
    v_mov_b32 v78, 2
    s_mov_b64 vcc, 0
    s_waitcnt vmcnt(5)
    s_cbranch_vccnz L_w22
    s_waitcnt vmcnt(4)
L_w22:
    buffer_load_dwordx4 v[128:131], v1, s[8:11], s28 offen nt
    s_xor_b32 s28, s26, 0x94400
    s_waitcnt lgkmcnt(0)
    v_cmp_lt_i32 vcc, 3, v78
    v_mov_b32 v79, 11
    ds_write_b32 v76, v79 offset:16384
    ds_read_b32 v78, v77 offset:256
    s_waitcnt vmcnt(5)
    s_cbranch_vccnz L_w23
    s_waitcnt vmcnt(4)
L_w23:
    buffer_load_dwordx4 v[132:135], v1, s[8:11], s28 offen nt
    s_xor_b32 s28, s26, 0x14800
    s_waitcnt vmcnt(5)
    s_cbranch_vccnz L_w24
    s_waitcnt vmcnt(4)
L_w24:
    buffer_load_dwordx4 v[136:139], v1, s[8:11], s28 offen nt
    s_xor_b32 s28, s26, 0x94c00
    s_waitcnt lgkmcnt(0)
    v_cmp_lt_i32 vcc, 0, v78
    v_mov_b32 v79, 12
    ds_write_b32 v76, v79 offset:16384
    ds_read_b32 v78, v77 offset:256
    s_waitcnt vmcnt(5)
    s_cbranch_vccnz L_w25
    s_waitcnt vmcnt(4)
L_w25:
    buffer_load_dwordx4 v[140:143], v1, s[8:11], s28 offen nt
    s_xor_b32 s28, s26, 0x20400
    s_waitcnt vmcnt(5)
    s_cbranch_vccnz L_w26
    s_waitcnt vmcnt(4)
L_w26:
    buffer_load_dwordx4 v[144:147], v1, s[8:11], s28 offen nt
    s_xor_b32 s28, s26, 0xa0000
    s_waitcnt lgkmcnt(0)
    v_cmp_lt_i32 vcc, 2, v78
    v_mov_b32 v79, 13
    ds_write_b32 v76, v79 offset:16384
    ds_read_b32 v78, v77 offset:256
    s_waitcnt vmcnt(5)
    s_cbranch_vccnz L_w27
    s_waitcnt vmcnt(4)
L_w27:
    buffer_load_dwordx4 v[148:151], v1, s[8:11], s28 offen nt
    s_xor_b32 s28, s26, 0x20c00
    s_waitcnt vmcnt(5)
    s_cbranch_vccnz L_w28
    s_waitcnt vmcnt(4)
L_w28:
    buffer_load_dwordx4 v[152:155], v1, s[8:11], s28 offen nt
    s_xor_b32 s28, s26, 0xa0800
L_pad7:
    s_cmp_eq_u32 s51, 1
    s_cbranch_scc1 L_pad8
    s_waitcnt lgkmcnt(0)
    v_cmp_lt_i32 vcc, 1, v78
    v_mov_b32 v79, 14
    ds_write_b32 v76, v79 offset:16384
    ds_read_b32 v78, v77 offset:256
    s_waitcnt vmcnt(5)
    s_cbranch_vccnz L_w29
    s_waitcnt vmcnt(4)
L_w29:
    buffer_load_dwordx4 v[156:159], v1, s[8:11], s28 offen nt
    s_xor_b32 s28, s26, 0x24400
    s_waitcnt vmcnt(5)
    s_cbranch_vccnz L_w30
    s_waitcnt vmcnt(4)
L_w30:
    buffer_load_dwordx4 v[160:163], v1, s[8:11], s28 offen nt
    s_xor_b32 s28, s26, 0xa4000
    s_waitcnt lgkmcnt(0)
    v_cmp_lt_i32 vcc, 3, v78
    v_mov_b32 v79, 15
    ds_write_b32 v76, v79 offset:16384
    ds_read_b32 v78, v77 offset:256
    s_waitcnt vmcnt(5)
    s_cbranch_vccnz L_w31
    s_waitcnt vmcnt(4)
L_w31:
    buffer_load_dwordx4 v[164:167], v1, s[8:11], s28 offen nt
    s_xor_b32 s28, s26, 0x24c00
    s_waitcnt vmcnt(5)
    s_cbranch_vccnz L_w32
    s_waitcnt vmcnt(4)
L_w32:
    buffer_load_dwordx4 v[168:171], v1, s[8:11], s28 offen nt
    s_xor_b32 s28, s26, 0xa4800
    s_waitcnt lgkmcnt(0)
    v_cmp_lt_i32 vcc, 0, v78
    v_mov_b32 v79, 16
    ds_write_b32 v76, v79 offset:16384
    ds_read_b32 v78, v77 offset:256
    s_waitcnt vmcnt(5)
    s_cbranch_vccnz L_w33
    s_waitcnt vmcnt(4)
L_w33:
    buffer_load_dwordx4 v[172:175], v1, s[8:11], s28 offen nt
    s_xor_b32 s28, s26, 0x30400
    s_waitcnt vmcnt(5)
    s_cbranch_vccnz L_w34
    s_waitcnt vmcnt(4)
L_w34:
    buffer_load_dwordx4 v[176:179], v1, s[8:11], s28 offen nt
    s_xor_b32 s28, s26, 0xb0000
    s_waitcnt lgkmcnt(0)
    v_cmp_lt_i32 vcc, 2, v78
    v_mov_b32 v79, 17
    ds_write_b32 v76, v79 offset:16384
    ds_read_b32 v78, v77 offset:256
    s_waitcnt vmcnt(5)
    s_cbranch_vccnz L_w35
    s_waitcnt vmcnt(4)
L_w35:
    buffer_load_dwordx4 v[180:183], v1, s[8:11], s28 offen nt
    s_xor_b32 s28, s26, 0x30c00
    s_waitcnt vmcnt(5)
    s_cbranch_vccnz L_w36
    s_waitcnt vmcnt(4)
L_w36:
    buffer_load_dwordx4 v[184:187], v1, s[8:11], s28 offen nt
    s_xor_b32 s28, s26, 0xb0800
    s_waitcnt lgkmcnt(0)
    v_cmp_lt_i32 vcc, 1, v78
    v_mov_b32 v79, 18
    ds_write_b32 v76, v79 offset:16384
    ds_read_b32 v78, v77 offset:256
    s_waitcnt vmcnt(5)
    s_cbranch_vccnz L_w37
    s_waitcnt vmcnt(4)
L_w37:
    buffer_load_dwordx4 v[188:191], v1, s[8:11], s28 offen nt
    s_xor_b32 s28, s26, 0x34400
    s_waitcnt vmcnt(5)
    s_cbranch_vccnz L_w38
    s_waitcnt vmcnt(4)
L_w38:
    buffer_load_dwordx4 v[192:195], v1, s[8:11], s28 offen nt
    s_xor_b32 s28, s26, 0xb4000
    s_waitcnt lgkmcnt(0)
    v_cmp_lt_i32 vcc, 3, v78
    v_mov_b32 v79, 19
    ds_write_b32 v76, v79 offset:16384
    ds_read_b32 v78, v77 offset:256
    s_waitcnt vmcnt(5)
    s_cbranch_vccnz L_w39
    s_waitcnt vmcnt(4)
L_w39:
    buffer_load_dwordx4 v[196:199], v1, s[8:11], s28 offen nt
    s_xor_b32 s28, s26, 0x34c00
    s_waitcnt vmcnt(5)
    s_cbranch_vccnz L_w40
    s_waitcnt vmcnt(4)
L_w40:
    buffer_load_dwordx4 v[200:203], v1, s[8:11], s28 offen nt
    s_xor_b32 s28, s26, 0xb4800
    s_waitcnt lgkmcnt(0)
    v_cmp_lt_i32 vcc, 0, v78
    v_mov_b32 v79, 20
    ds_write_b32 v76, v79 offset:16384
    ds_read_b32 v78, v77 offset:256
    s_waitcnt vmcnt(5)
    s_cbranch_vccnz L_w41
    s_waitcnt vmcnt(4)
L_w41:
    buffer_load_dwordx4 v[204:207], v1, s[8:11], s28 offen nt
    s_xor_b32 s28, s26, 0x101000
    s_waitcnt vmcnt(5)
    s_cbranch_vccnz L_w42
    s_waitcnt vmcnt(4)
L_w42:
    buffer_load_dwordx4 v[208:211], v1, s[8:11], s28 offen nt
    s_xor_b32 s28, s26, 0x181400
    s_waitcnt lgkmcnt(0)
    v_cmp_lt_i32 vcc, 2, v78
    v_mov_b32 v79, 21
    ds_write_b32 v76, v79 offset:16384
    ds_read_b32 v78, v77 offset:256
    s_waitcnt vmcnt(5)
    s_cbranch_vccnz L_w43
    s_waitcnt vmcnt(4)
L_w43:
    buffer_load_dwordx4 v[212:215], v1, s[8:11], s28 offen nt
    s_xor_b32 s28, s26, 0x101800
    s_waitcnt vmcnt(5)
    s_cbranch_vccnz L_w44
    s_waitcnt vmcnt(4)
L_w44:
    buffer_load_dwordx4 v[216:219], v1, s[8:11], s28 offen nt
    s_xor_b32 s28, s26, 0x181c00
    s_waitcnt lgkmcnt(0)
    v_cmp_lt_i32 vcc, 1, v78
    v_mov_b32 v79, 22
    ds_write_b32 v76, v79 offset:16384
    ds_read_b32 v78, v77 offset:256
    s_waitcnt vmcnt(5)
    s_cbranch_vccnz L_w45
    s_waitcnt vmcnt(4)
L_w45:
    buffer_load_dwordx4 v[220:223], v1, s[8:11], s28 offen nt
    s_xor_b32 s28, s26, 0x105000
    s_waitcnt vmcnt(5)
    s_cbranch_vccnz L_w46
    s_waitcnt vmcnt(4)
L_w46:
    buffer_load_dwordx4 v[224:227], v1, s[8:11], s28 offen nt
    s_xor_b32 s28, s26, 0x185400
    s_waitcnt lgkmcnt(0)
    v_cmp_lt_i32 vcc, 3, v78
    v_mov_b32 v79, 23
    ds_write_b32 v76, v79 offset:16384
    ds_read_b32 v78, v77 offset:256
    s_waitcnt vmcnt(5)
    s_cbranch_vccnz L_w47
    s_waitcnt vmcnt(4)
L_w47:
    buffer_load_dwordx4 v[228:231], v1, s[8:11], s28 offen nt
    s_xor_b32 s28, s26, 0x105800
    s_waitcnt vmcnt(5)
    s_cbranch_vccnz L_w48
    s_waitcnt vmcnt(4)
L_w48:
    buffer_load_dwordx4 v[232:235], v1, s[8:11], s28 offen nt
    s_xor_b32 s28, s26, 0x185c00
    s_waitcnt lgkmcnt(0)
    v_cmp_lt_i32 vcc, 0, v78
    v_mov_b32 v79, 24
    ds_write_b32 v76, v79 offset:16384
    ds_read_b32 v78, v77 offset:256
    s_waitcnt vmcnt(5)
    s_cbranch_vccnz L_w49
    s_waitcnt vmcnt(4)
L_w49:
    buffer_load_dwordx4 v[236:239], v1, s[8:11], s28 offen nt
    s_xor_b32 s28, s26, 0x111000
    s_waitcnt vmcnt(5)
    s_cbranch_vccnz L_w50
    s_waitcnt vmcnt(4)
L_w50:
    buffer_load_dwordx4 v[240:243], v1, s[8:11], s28 offen nt
    s_xor_b32 s28, s26, 0x191400
    s_waitcnt lgkmcnt(0)
    v_cmp_lt_i32 vcc, 2, v78
    v_mov_b32 v79, 25
    ds_write_b32 v76, v79 offset:16384
    ds_read_b32 v78, v77 offset:256
    s_waitcnt vmcnt(5)
    s_cbranch_vccnz L_w51
    s_waitcnt vmcnt(4)
L_w51:
    buffer_load_dwordx4 v[244:247], v1, s[8:11], s28 offen nt
    s_xor_b32 s28, s26, 0x111800
    s_waitcnt vmcnt(5)
    s_cbranch_vccnz L_w52
    s_waitcnt vmcnt(4)
L_w52:
    buffer_load_dwordx4 v[248:251], v1, s[8:11], s28 offen nt
    s_xor_b32 s28, s26, 0x191c00
L_pad8:
    s_cmp_eq_u32 s51, 1
    s_cbranch_scc1 L_pad9
    s_waitcnt lgkmcnt(0)
    v_cmp_lt_i32 vcc, 1, v78
    v_mov_b32 v79, 26
    ds_write_b32 v76, v79 offset:16384
    ds_read_b32 v78, v77 offset:256
    s_waitcnt vmcnt(5)
    s_cbranch_vccnz L_w53
    s_waitcnt vmcnt(4)
L_w53:
    buffer_load_dwordx4 v[252:255], v1, s[8:11], s28 offen nt
    s_xor_b32 s28, s26, 0x115000
    s_mov_b32 s50, 786432
    v_mov_b32 v3, 0
L_qw:
    ds_read_b64 v[28:29], v3 offset:0
    ds_read_b128 v[8:11], v2 offset:1024
    s_waitcnt lgkmcnt(0)
    v_cmp_ne_u32 vcc, 0, v28
    s_cbranch_vccnz L_qx
    s_sub_u32 s50, s50, 1
    s_cbranch_scc0 L_qw
L_qx:
    v_readfirstlane_b32 s36, v29
    v_mfma_f32_16x16x32_bf16 v[12:15], v[80:83], v[8:11], 0
    v_mfma_f32_16x16x32_bf16 v[16:19], v[84:87], v[8:11], 0
    s_waitcnt vmcnt(5)
    s_cbranch_vccnz L_w54
    s_waitcnt vmcnt(4)
L_w54:
    buffer_load_dwordx4 v[80:83], v1, s[8:11], s28 offen nt
    s_xor_b32 s28, s26, 0x195400
    v_mfma_f32_16x16x32_bf16 v[20:23], v[88:91], v[8:11], 0
    v_mfma_f32_16x16x32_bf16 v[24:27], v[92:95], v[8:11], 0
    s_nop 0
    v_mov_b32_dpp v28, v12 quad_perm:[0,0,0,0] row_mask:0xf bank_mask:0xf
    v_mov_b32_dpp v29, v14 quad_perm:[2,2,2,2] row_mask:0xf bank_mask:0xf
    v_mov_b32_dpp v30, v16 quad_perm:[0,0,0,0] row_mask:0xf bank_mask:0xf
    v_mov_b32_dpp v31, v18 quad_perm:[2,2,2,2] row_mask:0xf bank_mask:0xf
    v_add_f32_dpp v28, v13, v28 quad_perm:[1,1,1,1] row_mask:0xf bank_mask:0xf
    v_add_f32_dpp v29, v15, v29 quad_perm:[3,3,3,3] row_mask:0xf bank_mask:0xf
    v_add_f32_dpp v30, v17, v30 quad_perm:[1,1,1,1] row_mask:0xf bank_mask:0xf
    v_add_f32_dpp v31, v19, v31 quad_perm:[3,3,3,3] row_mask:0xf bank_mask:0xf
    v_add_f32 v44, v28, v29
    v_add_f32 v30, v30, v31
    v_cndmask_b32 v44, v44, v30, s[44:45]
    s_waitcnt lgkmcnt(0)
    v_cmp_lt_i32 vcc, 3, v78
    v_mov_b32 v79, 27
    ds_write_b32 v76, v79 offset:16384
    ds_read_b32 v78, v77 offset:256
    s_waitcnt vmcnt(5)
    s_cbranch_vccnz L_w55
    s_waitcnt vmcnt(4)
L_w55:
    buffer_load_dwordx4 v[84:87], v1, s[8:11], s28 offen nt
    s_xor_b32 s28, s26, 0x115800
    v_mfma_f32_16x16x32_bf16 v[12:15], v[96:99], v[8:11], 0
    v_mfma_f32_16x16x32_bf16 v[16:19], v[100:103], v[8:11], 0
    v_mov_b32_dpp v28, v20 quad_perm:[0,0,0,0] row_mask:0xf bank_mask:0xf
    v_mov_b32_dpp v29, v22 quad_perm:[2,2,2,2] row_mask:0xf bank_mask:0xf
    v_mov_b32_dpp v30, v24 quad_perm:[0,0,0,0] row_mask:0xf bank_mask:0xf
    v_mov_b32_dpp v31, v26 quad_perm:[2,2,2,2] row_mask:0xf bank_mask:0xf
    v_add_f32_dpp v28, v21, v28 quad_perm:[1,1,1,1] row_mask:0xf bank_mask:0xf
    v_add_f32_dpp v29, v23, v29 quad_perm:[3,3,3,3] row_mask:0xf bank_mask:0xf
    v_add_f32_dpp v30, v25, v30 quad_perm:[1,1,1,1] row_mask:0xf bank_mask:0xf
    v_add_f32_dpp v31, v27, v31 quad_perm:[3,3,3,3] row_mask:0xf bank_mask:0xf
    v_add_f32 v28, v28, v29
    v_cndmask_b32 v44, v44, v28, s[46:47]
    v_add_f32 v30, v30, v31
    v_cndmask_b32 v44, v44, v30, s[48:49]
    v_cvt_pk_bf16_f32 v44, v44, v44
    v_and_b32 v44, 0xffff0000, v44
    v_mul_f32 v44, 0x3db504f3, v44
    v_cvt_pk_bf16_f32 v44, v44, v44
    v_and_b32 v44, 0xffff0000, v44
    v_max_f32 v6, v6, v44
    s_waitcnt vmcnt(5)
    s_cbranch_vccnz L_w56
    s_waitcnt vmcnt(4)
L_w56:
    buffer_load_dwordx4 v[88:91], v1, s[8:11], s28 offen nt
    s_xor_b32 s28, s26, 0x195c00
    v_mfma_f32_16x16x32_bf16 v[20:23], v[104:107], v[8:11], 0
    v_mfma_f32_16x16x32_bf16 v[24:27], v[108:111], v[8:11], 0
    v_mov_b32_dpp v28, v12 quad_perm:[0,0,0,0] row_mask:0xf bank_mask:0xf
    v_mov_b32_dpp v29, v14 quad_perm:[2,2,2,2] row_mask:0xf bank_mask:0xf
    v_mov_b32_dpp v30, v16 quad_perm:[0,0,0,0] row_mask:0xf bank_mask:0xf
    v_mov_b32_dpp v31, v18 quad_perm:[2,2,2,2] row_mask:0xf bank_mask:0xf
    v_add_f32_dpp v28, v13, v28 quad_perm:[1,1,1,1] row_mask:0xf bank_mask:0xf
    v_add_f32_dpp v29, v15, v29 quad_perm:[3,3,3,3] row_mask:0xf bank_mask:0xf
    v_add_f32_dpp v30, v17, v30 quad_perm:[1,1,1,1] row_mask:0xf bank_mask:0xf
    v_add_f32_dpp v31, v19, v31 quad_perm:[3,3,3,3] row_mask:0xf bank_mask:0xf
    v_add_f32 v45, v28, v29
    v_add_f32 v30, v30, v31
    v_cndmask_b32 v45, v45, v30, s[44:45]
    s_waitcnt lgkmcnt(0)
    v_cmp_lt_i32 vcc, 0, v78
    v_mov_b32 v79, 28
    ds_write_b32 v76, v79 offset:16384
    ds_read_b32 v78, v77 offset:256
    s_waitcnt vmcnt(5)
    s_cbranch_vccnz L_w57
    s_waitcnt vmcnt(4)
L_w57:
    buffer_load_dwordx4 v[92:95], v1, s[8:11], s28 offen nt
    s_xor_b32 s28, s26, 0x121400
    v_mfma_f32_16x16x32_bf16 v[12:15], v[112:115], v[8:11], 0
    v_mfma_f32_16x16x32_bf16 v[16:19], v[116:119], v[8:11], 0
    v_mov_b32_dpp v28, v20 quad_perm:[0,0,0,0] row_mask:0xf bank_mask:0xf
    v_mov_b32_dpp v29, v22 quad_perm:[2,2,2,2] row_mask:0xf bank_mask:0xf
    v_mov_b32_dpp v30, v24 quad_perm:[0,0,0,0] row_mask:0xf bank_mask:0xf
    v_mov_b32_dpp v31, v26 quad_perm:[2,2,2,2] row_mask:0xf bank_mask:0xf
    v_add_f32_dpp v28, v21, v28 quad_perm:[1,1,1,1] row_mask:0xf bank_mask:0xf
    v_add_f32_dpp v29, v23, v29 quad_perm:[3,3,3,3] row_mask:0xf bank_mask:0xf
    v_add_f32_dpp v30, v25, v30 quad_perm:[1,1,1,1] row_mask:0xf bank_mask:0xf
    v_add_f32_dpp v31, v27, v31 quad_perm:[3,3,3,3] row_mask:0xf bank_mask:0xf
    v_add_f32 v28, v28, v29
    v_cndmask_b32 v45, v45, v28, s[46:47]
    v_add_f32 v30, v30, v31
    v_cndmask_b32 v45, v45, v30, s[48:49]
    v_cvt_pk_bf16_f32 v45, v45, v45
    v_and_b32 v45, 0xffff0000, v45
    v_mul_f32 v45, 0x3db504f3, v45
    v_cvt_pk_bf16_f32 v45, v45, v45
    v_and_b32 v45, 0xffff0000, v45
    v_max_f32 v6, v6, v45
    s_waitcnt vmcnt(5)
    s_cbranch_vccnz L_w58
    s_waitcnt vmcnt(4)
L_w58:
    buffer_load_dwordx4 v[96:99], v1, s[8:11], s28 offen nt
    s_xor_b32 s28, s26, 0x1a1000
    v_mfma_f32_16x16x32_bf16 v[20:23], v[120:123], v[8:11], 0
    v_mfma_f32_16x16x32_bf16 v[24:27], v[124:127], v[8:11], 0
    v_mov_b32_dpp v28, v12 quad_perm:[0,0,0,0] row_mask:0xf bank_mask:0xf
    v_mov_b32_dpp v29, v14 quad_perm:[2,2,2,2] row_mask:0xf bank_mask:0xf
    v_mov_b32_dpp v30, v16 quad_perm:[0,0,0,0] row_mask:0xf bank_mask:0xf
    v_mov_b32_dpp v31, v18 quad_perm:[2,2,2,2] row_mask:0xf bank_mask:0xf
    v_add_f32_dpp v28, v13, v28 quad_perm:[1,1,1,1] row_mask:0xf bank_mask:0xf
    v_add_f32_dpp v29, v15, v29 quad_perm:[3,3,3,3] row_mask:0xf bank_mask:0xf
    v_add_f32_dpp v30, v17, v30 quad_perm:[1,1,1,1] row_mask:0xf bank_mask:0xf
    v_add_f32_dpp v31, v19, v31 quad_perm:[3,3,3,3] row_mask:0xf bank_mask:0xf
    v_add_f32 v46, v28, v29
    v_add_f32 v30, v30, v31
    v_cndmask_b32 v46, v46, v30, s[44:45]
    s_waitcnt lgkmcnt(0)
    v_cmp_lt_i32 vcc, 2, v78
    v_mov_b32 v79, 29
    ds_write_b32 v76, v79 offset:16384
    ds_read_b32 v78, v77 offset:256
    s_waitcnt vmcnt(5)
    s_cbranch_vccnz L_w59
    s_waitcnt vmcnt(4)
L_w59:
    buffer_load_dwordx4 v[100:103], v1, s[8:11], s28 offen nt
    s_xor_b32 s28, s26, 0x121c00
    v_mfma_f32_16x16x32_bf16 v[12:15], v[128:131], v[8:11], 0
    v_mfma_f32_16x16x32_bf16 v[16:19], v[132:135], v[8:11], 0
    v_mov_b32_dpp v28, v20 quad_perm:[0,0,0,0] row_mask:0xf bank_mask:0xf
    v_mov_b32_dpp v29, v22 quad_perm:[2,2,2,2] row_mask:0xf bank_mask:0xf
    v_mov_b32_dpp v30, v24 quad_perm:[0,0,0,0] row_mask:0xf bank_mask:0xf
    v_mov_b32_dpp v31, v26 quad_perm:[2,2,2,2] row_mask:0xf bank_mask:0xf
    v_add_f32_dpp v28, v21, v28 quad_perm:[1,1,1,1] row_mask:0xf bank_mask:0xf
    v_add_f32_dpp v29, v23, v29 quad_perm:[3,3,3,3] row_mask:0xf bank_mask:0xf
    v_add_f32_dpp v30, v25, v30 quad_perm:[1,1,1,1] row_mask:0xf bank_mask:0xf
    v_add_f32_dpp v31, v27, v31 quad_perm:[3,3,3,3] row_mask:0xf bank_mask:0xf
L_pad9:
    s_cmp_eq_u32 s51, 1
    s_cbranch_scc1 L_pad10
    v_add_f32 v28, v28, v29
    v_cndmask_b32 v46, v46, v28, s[46:47]
    v_add_f32 v30, v30, v31
    v_cndmask_b32 v46, v46, v30, s[48:49]
    v_cvt_pk_bf16_f32 v46, v46, v46
    v_and_b32 v46, 0xffff0000, v46
    v_mul_f32 v46, 0x3db504f3, v46
    v_cvt_pk_bf16_f32 v46, v46, v46
    v_and_b32 v46, 0xffff0000, v46
    v_max_f32 v6, v6, v46
    s_waitcnt vmcnt(5)
    s_cbranch_vccnz L_w60
    s_waitcnt vmcnt(4)
L_w60:
    buffer_load_dwordx4 v[104:107], v1, s[8:11], s28 offen nt
    s_xor_b32 s28, s26, 0x1a1800
    v_mfma_f32_16x16x32_bf16 v[20:23], v[136:139], v[8:11], 0
    v_mfma_f32_16x16x32_bf16 v[24:27], v[140:143], v[8:11], 0
    v_mov_b32_dpp v28, v12 quad_perm:[0,0,0,0] row_mask:0xf bank_mask:0xf
    v_mov_b32_dpp v29, v14 quad_perm:[2,2,2,2] row_mask:0xf bank_mask:0xf
    v_mov_b32_dpp v30, v16 quad_perm:[0,0,0,0] row_mask:0xf bank_mask:0xf
    v_mov_b32_dpp v31, v18 quad_perm:[2,2,2,2] row_mask:0xf bank_mask:0xf
    v_add_f32_dpp v28, v13, v28 quad_perm:[1,1,1,1] row_mask:0xf bank_mask:0xf
    v_add_f32_dpp v29, v15, v29 quad_perm:[3,3,3,3] row_mask:0xf bank_mask:0xf
    v_add_f32_dpp v30, v17, v30 quad_perm:[1,1,1,1] row_mask:0xf bank_mask:0xf
    v_add_f32_dpp v31, v19, v31 quad_perm:[3,3,3,3] row_mask:0xf bank_mask:0xf
    v_add_f32 v47, v28, v29
    v_add_f32 v30, v30, v31
    v_cndmask_b32 v47, v47, v30, s[44:45]
    s_waitcnt lgkmcnt(0)
    v_cmp_lt_i32 vcc, 1, v78
    v_mov_b32 v79, 30
    ds_write_b32 v76, v79 offset:16384
    ds_read_b32 v78, v77 offset:256
    s_waitcnt vmcnt(5)
    s_cbranch_vccnz L_w61
    s_waitcnt vmcnt(4)
L_w61:
    buffer_load_dwordx4 v[108:111], v1, s[8:11], s28 offen nt
    s_xor_b32 s28, s26, 0x125400
    v_mfma_f32_16x16x32_bf16 v[12:15], v[144:147], v[8:11], 0
    v_mfma_f32_16x16x32_bf16 v[16:19], v[148:151], v[8:11], 0
    v_mov_b32_dpp v28, v20 quad_perm:[0,0,0,0] row_mask:0xf bank_mask:0xf
    v_mov_b32_dpp v29, v22 quad_perm:[2,2,2,2] row_mask:0xf bank_mask:0xf
    v_mov_b32_dpp v30, v24 quad_perm:[0,0,0,0] row_mask:0xf bank_mask:0xf
    v_mov_b32_dpp v31, v26 quad_perm:[2,2,2,2] row_mask:0xf bank_mask:0xf
    v_add_f32_dpp v28, v21, v28 quad_perm:[1,1,1,1] row_mask:0xf bank_mask:0xf
    v_add_f32_dpp v29, v23, v29 quad_perm:[3,3,3,3] row_mask:0xf bank_mask:0xf
    v_add_f32_dpp v30, v25, v30 quad_perm:[1,1,1,1] row_mask:0xf bank_mask:0xf
    v_add_f32_dpp v31, v27, v31 quad_perm:[3,3,3,3] row_mask:0xf bank_mask:0xf
    v_add_f32 v28, v28, v29
    v_cndmask_b32 v47, v47, v28, s[46:47]
    v_add_f32 v30, v30, v31
    v_cndmask_b32 v47, v47, v30, s[48:49]
    v_cvt_pk_bf16_f32 v47, v47, v47
    v_and_b32 v47, 0xffff0000, v47
    v_mul_f32 v47, 0x3db504f3, v47
    v_cvt_pk_bf16_f32 v47, v47, v47
    v_and_b32 v47, 0xffff0000, v47
    v_max_f32 v6, v6, v47
    s_waitcnt vmcnt(5)
    s_cbranch_vccnz L_w62
    s_waitcnt vmcnt(4)
L_w62:
    buffer_load_dwordx4 v[112:115], v1, s[8:11], s28 offen nt
    s_xor_b32 s28, s26, 0x1a5000
    v_mfma_f32_16x16x32_bf16 v[20:23], v[152:155], v[8:11], 0
    v_mfma_f32_16x16x32_bf16 v[24:27], v[156:159], v[8:11], 0
    v_mov_b32_dpp v28, v12 quad_perm:[0,0,0,0] row_mask:0xf bank_mask:0xf
    v_mov_b32_dpp v29, v14 quad_perm:[2,2,2,2] row_mask:0xf bank_mask:0xf
    v_mov_b32_dpp v30, v16 quad_perm:[0,0,0,0] row_mask:0xf bank_mask:0xf
    v_mov_b32_dpp v31, v18 quad_perm:[2,2,2,2] row_mask:0xf bank_mask:0xf
    v_add_f32_dpp v28, v13, v28 quad_perm:[1,1,1,1] row_mask:0xf bank_mask:0xf
    v_add_f32_dpp v29, v15, v29 quad_perm:[3,3,3,3] row_mask:0xf bank_mask:0xf
    v_add_f32_dpp v30, v17, v30 quad_perm:[1,1,1,1] row_mask:0xf bank_mask:0xf
    v_add_f32_dpp v31, v19, v31 quad_perm:[3,3,3,3] row_mask:0xf bank_mask:0xf
    v_add_f32 v48, v28, v29
    v_add_f32 v30, v30, v31
    v_cndmask_b32 v48, v48, v30, s[44:45]
    s_waitcnt lgkmcnt(0)
    v_cmp_lt_i32 vcc, 3, v78
    v_mov_b32 v79, 31
    ds_write_b32 v76, v79 offset:16384
    ds_read_b32 v78, v77 offset:256
    s_waitcnt vmcnt(5)
    s_cbranch_vccnz L_w63
    s_waitcnt vmcnt(4)
L_w63:
    buffer_load_dwordx4 v[116:119], v1, s[8:11], s28 offen nt
    s_xor_b32 s28, s26, 0x125c00
    v_mfma_f32_16x16x32_bf16 v[12:15], v[160:163], v[8:11], 0
    v_mfma_f32_16x16x32_bf16 v[16:19], v[164:167], v[8:11], 0
    v_mov_b32_dpp v28, v20 quad_perm:[0,0,0,0] row_mask:0xf bank_mask:0xf
    v_mov_b32_dpp v29, v22 quad_perm:[2,2,2,2] row_mask:0xf bank_mask:0xf
    v_mov_b32_dpp v30, v24 quad_perm:[0,0,0,0] row_mask:0xf bank_mask:0xf
    v_mov_b32_dpp v31, v26 quad_perm:[2,2,2,2] row_mask:0xf bank_mask:0xf
    v_add_f32_dpp v28, v21, v28 quad_perm:[1,1,1,1] row_mask:0xf bank_mask:0xf
    v_add_f32_dpp v29, v23, v29 quad_perm:[3,3,3,3] row_mask:0xf bank_mask:0xf
    v_add_f32_dpp v30, v25, v30 quad_perm:[1,1,1,1] row_mask:0xf bank_mask:0xf
    v_add_f32_dpp v31, v27, v31 quad_perm:[3,3,3,3] row_mask:0xf bank_mask:0xf
    v_add_f32 v28, v28, v29
    v_cndmask_b32 v48, v48, v28, s[46:47]
    v_add_f32 v30, v30, v31
    v_cndmask_b32 v48, v48, v30, s[48:49]
    v_cvt_pk_bf16_f32 v48, v48, v48
    v_and_b32 v48, 0xffff0000, v48
    v_mul_f32 v48, 0x3db504f3, v48
    v_cvt_pk_bf16_f32 v48, v48, v48
    v_and_b32 v48, 0xffff0000, v48
    v_max_f32 v6, v6, v48
    s_waitcnt vmcnt(5)
    s_cbranch_vccnz L_w64
    s_waitcnt vmcnt(4)
L_w64:
    buffer_load_dwordx4 v[120:123], v1, s[8:11], s28 offen nt
    s_xor_b32 s28, s26, 0x1a5800
    v_mfma_f32_16x16x32_bf16 v[20:23], v[168:171], v[8:11], 0
    v_mfma_f32_16x16x32_bf16 v[24:27], v[172:175], v[8:11], 0
    v_mov_b32_dpp v28, v12 quad_perm:[0,0,0,0] row_mask:0xf bank_mask:0xf
    v_mov_b32_dpp v29, v14 quad_perm:[2,2,2,2] row_mask:0xf bank_mask:0xf
    v_mov_b32_dpp v30, v16 quad_perm:[0,0,0,0] row_mask:0xf bank_mask:0xf
    v_mov_b32_dpp v31, v18 quad_perm:[2,2,2,2] row_mask:0xf bank_mask:0xf
    v_add_f32_dpp v28, v13, v28 quad_perm:[1,1,1,1] row_mask:0xf bank_mask:0xf
    v_add_f32_dpp v29, v15, v29 quad_perm:[3,3,3,3] row_mask:0xf bank_mask:0xf
    v_add_f32_dpp v30, v17, v30 quad_perm:[1,1,1,1] row_mask:0xf bank_mask:0xf
    v_add_f32_dpp v31, v19, v31 quad_perm:[3,3,3,3] row_mask:0xf bank_mask:0xf
    v_add_f32 v49, v28, v29
    v_add_f32 v30, v30, v31
    v_cndmask_b32 v49, v49, v30, s[44:45]
    s_waitcnt lgkmcnt(0)
    v_cmp_lt_i32 vcc, 0, v78
    v_mov_b32 v79, 32
    ds_write_b32 v76, v79 offset:16384
    ds_read_b32 v78, v77 offset:256
    s_waitcnt vmcnt(5)
    s_cbranch_vccnz L_w65
    s_waitcnt vmcnt(4)
L_w65:
    buffer_load_dwordx4 v[124:127], v1, s[8:11], s28 offen nt
    s_xor_b32 s28, s26, 0x131400
    v_mfma_f32_16x16x32_bf16 v[12:15], v[176:179], v[8:11], 0
    v_mfma_f32_16x16x32_bf16 v[16:19], v[180:183], v[8:11], 0
    v_mov_b32_dpp v28, v20 quad_perm:[0,0,0,0] row_mask:0xf bank_mask:0xf
    v_mov_b32_dpp v29, v22 quad_perm:[2,2,2,2] row_mask:0xf bank_mask:0xf
    v_mov_b32_dpp v30, v24 quad_perm:[0,0,0,0] row_mask:0xf bank_mask:0xf
    v_mov_b32_dpp v31, v26 quad_perm:[2,2,2,2] row_mask:0xf bank_mask:0xf
    v_add_f32_dpp v28, v21, v28 quad_perm:[1,1,1,1] row_mask:0xf bank_mask:0xf
    v_add_f32_dpp v29, v23, v29 quad_perm:[3,3,3,3] row_mask:0xf bank_mask:0xf
    v_add_f32_dpp v30, v25, v30 quad_perm:[1,1,1,1] row_mask:0xf bank_mask:0xf
    v_add_f32_dpp v31, v27, v31 quad_perm:[3,3,3,3] row_mask:0xf bank_mask:0xf
    v_add_f32 v28, v28, v29
    v_cndmask_b32 v49, v49, v28, s[46:47]
L_pad10:
    s_cmp_eq_u32 s51, 1
    s_cbranch_scc1 L_pad11
    v_add_f32 v30, v30, v31
    v_cndmask_b32 v49, v49, v30, s[48:49]
    v_cvt_pk_bf16_f32 v49, v49, v49
    v_and_b32 v49, 0xffff0000, v49
    v_mul_f32 v49, 0x3db504f3, v49
    v_cvt_pk_bf16_f32 v49, v49, v49
    v_and_b32 v49, 0xffff0000, v49
    v_max_f32 v6, v6, v49
    s_waitcnt vmcnt(5)
    s_cbranch_vccnz L_w66
    s_waitcnt vmcnt(4)
L_w66:
    buffer_load_dwordx4 v[128:131], v1, s[8:11], s28 offen nt
    s_xor_b32 s28, s26, 0x1b1000
    v_mfma_f32_16x16x32_bf16 v[20:23], v[184:187], v[8:11], 0
    v_mfma_f32_16x16x32_bf16 v[24:27], v[188:191], v[8:11], 0
    v_mov_b32_dpp v28, v12 quad_perm:[0,0,0,0] row_mask:0xf bank_mask:0xf
    v_mov_b32_dpp v29, v14 quad_perm:[2,2,2,2] row_mask:0xf bank_mask:0xf
    v_mov_b32_dpp v30, v16 quad_perm:[0,0,0,0] row_mask:0xf bank_mask:0xf
    v_mov_b32_dpp v31, v18 quad_perm:[2,2,2,2] row_mask:0xf bank_mask:0xf
    v_add_f32_dpp v28, v13, v28 quad_perm:[1,1,1,1] row_mask:0xf bank_mask:0xf
    v_add_f32_dpp v29, v15, v29 quad_perm:[3,3,3,3] row_mask:0xf bank_mask:0xf
    v_add_f32_dpp v30, v17, v30 quad_perm:[1,1,1,1] row_mask:0xf bank_mask:0xf
    v_add_f32_dpp v31, v19, v31 quad_perm:[3,3,3,3] row_mask:0xf bank_mask:0xf
    v_add_f32 v50, v28, v29
    v_add_f32 v30, v30, v31
    v_cndmask_b32 v50, v50, v30, s[44:45]
    s_waitcnt lgkmcnt(0)
    v_cmp_lt_i32 vcc, 2, v78
    v_mov_b32 v79, 33
    ds_write_b32 v76, v79 offset:16384
    ds_read_b32 v78, v77 offset:256
    s_waitcnt vmcnt(5)
    s_cbranch_vccnz L_w67
    s_waitcnt vmcnt(4)
L_w67:
    buffer_load_dwordx4 v[132:135], v1, s[8:11], s28 offen nt
    s_xor_b32 s28, s26, 0x131c00
    v_mfma_f32_16x16x32_bf16 v[12:15], v[192:195], v[8:11], 0
    v_mfma_f32_16x16x32_bf16 v[16:19], v[196:199], v[8:11], 0
    v_mov_b32_dpp v28, v20 quad_perm:[0,0,0,0] row_mask:0xf bank_mask:0xf
    v_mov_b32_dpp v29, v22 quad_perm:[2,2,2,2] row_mask:0xf bank_mask:0xf
    v_mov_b32_dpp v30, v24 quad_perm:[0,0,0,0] row_mask:0xf bank_mask:0xf
    v_mov_b32_dpp v31, v26 quad_perm:[2,2,2,2] row_mask:0xf bank_mask:0xf
    v_add_f32_dpp v28, v21, v28 quad_perm:[1,1,1,1] row_mask:0xf bank_mask:0xf
    v_add_f32_dpp v29, v23, v29 quad_perm:[3,3,3,3] row_mask:0xf bank_mask:0xf
    v_add_f32_dpp v30, v25, v30 quad_perm:[1,1,1,1] row_mask:0xf bank_mask:0xf
    v_add_f32_dpp v31, v27, v31 quad_perm:[3,3,3,3] row_mask:0xf bank_mask:0xf
    v_add_f32 v28, v28, v29
    v_cndmask_b32 v50, v50, v28, s[46:47]
    v_add_f32 v30, v30, v31
    v_cndmask_b32 v50, v50, v30, s[48:49]
    v_cvt_pk_bf16_f32 v50, v50, v50
    v_and_b32 v50, 0xffff0000, v50
    v_mul_f32 v50, 0x3db504f3, v50
    v_cvt_pk_bf16_f32 v50, v50, v50
    v_and_b32 v50, 0xffff0000, v50
    v_max_f32 v6, v6, v50
    s_waitcnt vmcnt(5)
    s_cbranch_vccnz L_w68
    s_waitcnt vmcnt(4)
L_w68:
    buffer_load_dwordx4 v[136:139], v1, s[8:11], s28 offen nt
    s_xor_b32 s28, s26, 0x1b1800
    v_mfma_f32_16x16x32_bf16 v[20:23], v[200:203], v[8:11], 0
    v_mfma_f32_16x16x32_bf16 v[24:27], v[204:207], v[8:11], 0
    v_mov_b32_dpp v28, v12 quad_perm:[0,0,0,0] row_mask:0xf bank_mask:0xf
    v_mov_b32_dpp v29, v14 quad_perm:[2,2,2,2] row_mask:0xf bank_mask:0xf
    v_mov_b32_dpp v30, v16 quad_perm:[0,0,0,0] row_mask:0xf bank_mask:0xf
    v_mov_b32_dpp v31, v18 quad_perm:[2,2,2,2] row_mask:0xf bank_mask:0xf
    v_add_f32_dpp v28, v13, v28 quad_perm:[1,1,1,1] row_mask:0xf bank_mask:0xf
    v_add_f32_dpp v29, v15, v29 quad_perm:[3,3,3,3] row_mask:0xf bank_mask:0xf
    v_add_f32_dpp v30, v17, v30 quad_perm:[1,1,1,1] row_mask:0xf bank_mask:0xf
    v_add_f32_dpp v31, v19, v31 quad_perm:[3,3,3,3] row_mask:0xf bank_mask:0xf
    v_add_f32 v51, v28, v29
    v_add_f32 v30, v30, v31
    v_cndmask_b32 v51, v51, v30, s[44:45]
    s_waitcnt lgkmcnt(0)
    v_cmp_lt_i32 vcc, 1, v78
    v_mov_b32 v79, 34
    ds_write_b32 v76, v79 offset:16384
    ds_read_b32 v78, v77 offset:256
    s_waitcnt vmcnt(5)
    s_cbranch_vccnz L_w69
    s_waitcnt vmcnt(4)
L_w69:
    buffer_load_dwordx4 v[140:143], v1, s[8:11], s28 offen nt
    s_xor_b32 s28, s26, 0x135400
    v_mfma_f32_16x16x32_bf16 v[12:15], v[208:211], v[8:11], 0
    v_mfma_f32_16x16x32_bf16 v[16:19], v[212:215], v[8:11], 0
    v_mov_b32_dpp v28, v20 quad_perm:[0,0,0,0] row_mask:0xf bank_mask:0xf
    v_mov_b32_dpp v29, v22 quad_perm:[2,2,2,2] row_mask:0xf bank_mask:0xf
    v_mov_b32_dpp v30, v24 quad_perm:[0,0,0,0] row_mask:0xf bank_mask:0xf
    v_mov_b32_dpp v31, v26 quad_perm:[2,2,2,2] row_mask:0xf bank_mask:0xf
    v_add_f32_dpp v28, v21, v28 quad_perm:[1,1,1,1] row_mask:0xf bank_mask:0xf
    v_add_f32_dpp v29, v23, v29 quad_perm:[3,3,3,3] row_mask:0xf bank_mask:0xf
    v_add_f32_dpp v30, v25, v30 quad_perm:[1,1,1,1] row_mask:0xf bank_mask:0xf
    v_add_f32_dpp v31, v27, v31 quad_perm:[3,3,3,3] row_mask:0xf bank_mask:0xf
    v_add_f32 v28, v28, v29
    v_cndmask_b32 v51, v51, v28, s[46:47]
    v_add_f32 v30, v30, v31
    v_cndmask_b32 v51, v51, v30, s[48:49]
    v_cvt_pk_bf16_f32 v51, v51, v51
    v_and_b32 v51, 0xffff0000, v51
    v_mul_f32 v51, 0x3db504f3, v51
    v_cvt_pk_bf16_f32 v51, v51, v51
    v_and_b32 v51, 0xffff0000, v51
    v_max_f32 v6, v6, v51
    s_waitcnt vmcnt(5)
    s_cbranch_vccnz L_w70
    s_waitcnt vmcnt(4)
L_w70:
    buffer_load_dwordx4 v[144:147], v1, s[8:11], s28 offen nt
    s_xor_b32 s28, s26, 0x1b5000
    v_mfma_f32_16x16x32_bf16 v[20:23], v[216:219], v[8:11], 0
    v_mfma_f32_16x16x32_bf16 v[24:27], v[220:223], v[8:11], 0
    v_mov_b32_dpp v28, v12 quad_perm:[0,0,0,0] row_mask:0xf bank_mask:0xf
    v_mov_b32_dpp v29, v14 quad_perm:[2,2,2,2] row_mask:0xf bank_mask:0xf
    v_mov_b32_dpp v30, v16 quad_perm:[0,0,0,0] row_mask:0xf bank_mask:0xf
    v_mov_b32_dpp v31, v18 quad_perm:[2,2,2,2] row_mask:0xf bank_mask:0xf
    v_add_f32_dpp v28, v13, v28 quad_perm:[1,1,1,1] row_mask:0xf bank_mask:0xf
    v_add_f32_dpp v29, v15, v29 quad_perm:[3,3,3,3] row_mask:0xf bank_mask:0xf
    v_add_f32_dpp v30, v17, v30 quad_perm:[1,1,1,1] row_mask:0xf bank_mask:0xf
    v_add_f32_dpp v31, v19, v31 quad_perm:[3,3,3,3] row_mask:0xf bank_mask:0xf
    v_add_f32 v52, v28, v29
    v_add_f32 v30, v30, v31
    v_cndmask_b32 v52, v52, v30, s[44:45]
    s_waitcnt lgkmcnt(0)
    v_cmp_lt_i32 vcc, 3, v78
    v_mov_b32 v79, 35
    ds_write_b32 v76, v79 offset:16384
    ds_read_b32 v78, v77 offset:256
    s_waitcnt vmcnt(5)
    s_cbranch_vccnz L_w71
    s_waitcnt vmcnt(4)
L_w71:
    buffer_load_dwordx4 v[148:151], v1, s[8:11], s28 offen nt
    s_xor_b32 s28, s26, 0x135c00
    v_mfma_f32_16x16x32_bf16 v[12:15], v[224:227], v[8:11], 0
    v_mfma_f32_16x16x32_bf16 v[16:19], v[228:231], v[8:11], 0
    v_mov_b32_dpp v28, v20 quad_perm:[0,0,0,0] row_mask:0xf bank_mask:0xf
    v_mov_b32_dpp v29, v22 quad_perm:[2,2,2,2] row_mask:0xf bank_mask:0xf
    v_mov_b32_dpp v30, v24 quad_perm:[0,0,0,0] row_mask:0xf bank_mask:0xf
    v_mov_b32_dpp v31, v26 quad_perm:[2,2,2,2] row_mask:0xf bank_mask:0xf
    v_add_f32_dpp v28, v21, v28 quad_perm:[1,1,1,1] row_mask:0xf bank_mask:0xf
    v_add_f32_dpp v29, v23, v29 quad_perm:[3,3,3,3] row_mask:0xf bank_mask:0xf
    v_add_f32_dpp v30, v25, v30 quad_perm:[1,1,1,1] row_mask:0xf bank_mask:0xf
    v_add_f32_dpp v31, v27, v31 quad_perm:[3,3,3,3] row_mask:0xf bank_mask:0xf
    v_add_f32 v28, v28, v29
    v_cndmask_b32 v52, v52, v28, s[46:47]
    v_add_f32 v30, v30, v31
    v_cndmask_b32 v52, v52, v30, s[48:49]
    v_cvt_pk_bf16_f32 v52, v52, v52
    v_and_b32 v52, 0xffff0000, v52
    v_mul_f32 v52, 0x3db504f3, v52
    v_cvt_pk_bf16_f32 v52, v52, v52
    v_and_b32 v52, 0xffff0000, v52
    v_max_f32 v6, v6, v52
L_pad11:
    s_cmp_eq_u32 s51, 1
    s_cbranch_scc1 L_pad12
    s_waitcnt vmcnt(5)
    s_cbranch_vccnz L_w72
    s_waitcnt vmcnt(4)
L_w72:
    buffer_load_dwordx4 v[152:155], v1, s[8:11], s28 offen nt
    s_xor_b32 s28, s26, 0x1b5800
    v_mfma_f32_16x16x32_bf16 v[20:23], v[232:235], v[8:11], 0
    v_mfma_f32_16x16x32_bf16 v[24:27], v[236:239], v[8:11], 0
    v_mov_b32_dpp v28, v12 quad_perm:[0,0,0,0] row_mask:0xf bank_mask:0xf
    v_mov_b32_dpp v29, v14 quad_perm:[2,2,2,2] row_mask:0xf bank_mask:0xf
    v_mov_b32_dpp v30, v16 quad_perm:[0,0,0,0] row_mask:0xf bank_mask:0xf
    v_mov_b32_dpp v31, v18 quad_perm:[2,2,2,2] row_mask:0xf bank_mask:0xf
    v_add_f32_dpp v28, v13, v28 quad_perm:[1,1,1,1] row_mask:0xf bank_mask:0xf
    v_add_f32_dpp v29, v15, v29 quad_perm:[3,3,3,3] row_mask:0xf bank_mask:0xf
    v_add_f32_dpp v30, v17, v30 quad_perm:[1,1,1,1] row_mask:0xf bank_mask:0xf
    v_add_f32_dpp v31, v19, v31 quad_perm:[3,3,3,3] row_mask:0xf bank_mask:0xf
    v_add_f32 v53, v28, v29
    v_add_f32 v30, v30, v31
    v_cndmask_b32 v53, v53, v30, s[44:45]
    s_waitcnt lgkmcnt(0)
    v_cmp_lt_i32 vcc, 0, v78
    v_mov_b32 v79, 36
    ds_write_b32 v76, v79 offset:16384
    ds_read_b32 v78, v77 offset:256
    s_waitcnt vmcnt(5)
    s_cbranch_vccnz L_w73
    s_waitcnt vmcnt(4)
L_w73:
    buffer_load_dwordx4 v[156:159], v1, s[8:11], s28 offen nt
    s_xor_b32 s28, s26, 0x408000
    v_mfma_f32_16x16x32_bf16 v[12:15], v[240:243], v[8:11], 0
    v_mfma_f32_16x16x32_bf16 v[16:19], v[244:247], v[8:11], 0
    v_mov_b32_dpp v28, v20 quad_perm:[0,0,0,0] row_mask:0xf bank_mask:0xf
    v_mov_b32_dpp v29, v22 quad_perm:[2,2,2,2] row_mask:0xf bank_mask:0xf
    v_mov_b32_dpp v30, v24 quad_perm:[0,0,0,0] row_mask:0xf bank_mask:0xf
    v_mov_b32_dpp v31, v26 quad_perm:[2,2,2,2] row_mask:0xf bank_mask:0xf
    v_add_f32_dpp v28, v21, v28 quad_perm:[1,1,1,1] row_mask:0xf bank_mask:0xf
    v_add_f32_dpp v29, v23, v29 quad_perm:[3,3,3,3] row_mask:0xf bank_mask:0xf
    v_add_f32_dpp v30, v25, v30 quad_perm:[1,1,1,1] row_mask:0xf bank_mask:0xf
    v_add_f32_dpp v31, v27, v31 quad_perm:[3,3,3,3] row_mask:0xf bank_mask:0xf
    v_add_f32 v28, v28, v29
    v_cndmask_b32 v53, v53, v28, s[46:47]
    v_add_f32 v30, v30, v31
    v_cndmask_b32 v53, v53, v30, s[48:49]
    v_cvt_pk_bf16_f32 v53, v53, v53
    v_and_b32 v53, 0xffff0000, v53
    v_mul_f32 v53, 0x3db504f3, v53
    v_cvt_pk_bf16_f32 v53, v53, v53
    v_and_b32 v53, 0xffff0000, v53
    v_max_f32 v6, v6, v53
    s_waitcnt vmcnt(5)
    s_cbranch_vccnz L_w74
    s_waitcnt vmcnt(4)
L_w74:
    buffer_load_dwordx4 v[160:163], v1, s[8:11], s28 offen nt
    s_xor_b32 s28, s26, 0x488400
    v_mfma_f32_16x16x32_bf16 v[20:23], v[248:251], v[8:11], 0
    v_mfma_f32_16x16x32_bf16 v[24:27], v[252:255], v[8:11], 0
    v_mov_b32_dpp v28, v12 quad_perm:[0,0,0,0] row_mask:0xf bank_mask:0xf
    v_mov_b32_dpp v29, v14 quad_perm:[2,2,2,2] row_mask:0xf bank_mask:0xf
    v_mov_b32_dpp v30, v16 quad_perm:[0,0,0,0] row_mask:0xf bank_mask:0xf
    v_mov_b32_dpp v31, v18 quad_perm:[2,2,2,2] row_mask:0xf bank_mask:0xf
    v_add_f32_dpp v28, v13, v28 quad_perm:[1,1,1,1] row_mask:0xf bank_mask:0xf
    v_add_f32_dpp v29, v15, v29 quad_perm:[3,3,3,3] row_mask:0xf bank_mask:0xf
    v_add_f32_dpp v30, v17, v30 quad_perm:[1,1,1,1] row_mask:0xf bank_mask:0xf
    v_add_f32_dpp v31, v19, v31 quad_perm:[3,3,3,3] row_mask:0xf bank_mask:0xf
    v_add_f32 v54, v28, v29
    v_add_f32 v30, v30, v31
    v_cndmask_b32 v54, v54, v30, s[44:45]
    s_waitcnt lgkmcnt(0)
    v_cmp_lt_i32 vcc, 2, v78
    v_mov_b32 v79, 37
    ds_write_b32 v76, v79 offset:16384
    ds_read_b32 v78, v77 offset:256
    s_waitcnt vmcnt(5)
    s_cbranch_vccnz L_w75
    s_waitcnt vmcnt(4)
L_w75:
    buffer_load_dwordx4 v[164:167], v1, s[8:11], s28 offen nt
    s_xor_b32 s28, s26, 0x408800
    v_mfma_f32_16x16x32_bf16 v[12:15], v[80:83], v[8:11], 0
    v_mfma_f32_16x16x32_bf16 v[16:19], v[84:87], v[8:11], 0
    v_mov_b32_dpp v28, v20 quad_perm:[0,0,0,0] row_mask:0xf bank_mask:0xf
    v_mov_b32_dpp v29, v22 quad_perm:[2,2,2,2] row_mask:0xf bank_mask:0xf
    v_mov_b32_dpp v30, v24 quad_perm:[0,0,0,0] row_mask:0xf bank_mask:0xf
    v_mov_b32_dpp v31, v26 quad_perm:[2,2,2,2] row_mask:0xf bank_mask:0xf
    v_add_f32_dpp v28, v21, v28 quad_perm:[1,1,1,1] row_mask:0xf bank_mask:0xf
    v_add_f32_dpp v29, v23, v29 quad_perm:[3,3,3,3] row_mask:0xf bank_mask:0xf
    v_add_f32_dpp v30, v25, v30 quad_perm:[1,1,1,1] row_mask:0xf bank_mask:0xf
    v_add_f32_dpp v31, v27, v31 quad_perm:[3,3,3,3] row_mask:0xf bank_mask:0xf
    v_add_f32 v28, v28, v29
    v_cndmask_b32 v54, v54, v28, s[46:47]
    v_add_f32 v30, v30, v31
    v_cndmask_b32 v54, v54, v30, s[48:49]
    v_cvt_pk_bf16_f32 v54, v54, v54
    v_and_b32 v54, 0xffff0000, v54
    v_mul_f32 v54, 0x3db504f3, v54
    v_cvt_pk_bf16_f32 v54, v54, v54
    v_and_b32 v54, 0xffff0000, v54
    v_max_f32 v6, v6, v54
    s_waitcnt vmcnt(5)
    s_cbranch_vccnz L_w76
    s_waitcnt vmcnt(4)
L_w76:
    buffer_load_dwordx4 v[168:171], v1, s[8:11], s28 offen nt
    s_xor_b32 s28, s26, 0x488c00
    v_mfma_f32_16x16x32_bf16 v[20:23], v[88:91], v[8:11], 0
    v_mfma_f32_16x16x32_bf16 v[24:27], v[92:95], v[8:11], 0
    v_mov_b32_dpp v28, v12 quad_perm:[0,0,0,0] row_mask:0xf bank_mask:0xf
    v_mov_b32_dpp v29, v14 quad_perm:[2,2,2,2] row_mask:0xf bank_mask:0xf
    v_mov_b32_dpp v30, v16 quad_perm:[0,0,0,0] row_mask:0xf bank_mask:0xf
    v_mov_b32_dpp v31, v18 quad_perm:[2,2,2,2] row_mask:0xf bank_mask:0xf
    v_add_f32_dpp v28, v13, v28 quad_perm:[1,1,1,1] row_mask:0xf bank_mask:0xf
    v_add_f32_dpp v29, v15, v29 quad_perm:[3,3,3,3] row_mask:0xf bank_mask:0xf
    v_add_f32_dpp v30, v17, v30 quad_perm:[1,1,1,1] row_mask:0xf bank_mask:0xf
    v_add_f32_dpp v31, v19, v31 quad_perm:[3,3,3,3] row_mask:0xf bank_mask:0xf
    v_add_f32 v55, v28, v29
    v_add_f32 v30, v30, v31
    v_cndmask_b32 v55, v55, v30, s[44:45]
    s_waitcnt lgkmcnt(0)
    v_cmp_lt_i32 vcc, 1, v78
    v_mov_b32 v79, 38
    ds_write_b32 v76, v79 offset:16384
    ds_read_b32 v78, v77 offset:256
    s_waitcnt vmcnt(5)
    s_cbranch_vccnz L_w77
    s_waitcnt vmcnt(4)
L_w77:
    buffer_load_dwordx4 v[172:175], v1, s[8:11], s28 offen nt
    s_xor_b32 s28, s26, 0x40c000
    v_mfma_f32_16x16x32_bf16 v[12:15], v[96:99], v[8:11], 0
    v_mfma_f32_16x16x32_bf16 v[16:19], v[100:103], v[8:11], 0
    v_mov_b32_dpp v28, v20 quad_perm:[0,0,0,0] row_mask:0xf bank_mask:0xf
    v_mov_b32_dpp v29, v22 quad_perm:[2,2,2,2] row_mask:0xf bank_mask:0xf
    v_mov_b32_dpp v30, v24 quad_perm:[0,0,0,0] row_mask:0xf bank_mask:0xf
    v_mov_b32_dpp v31, v26 quad_perm:[2,2,2,2] row_mask:0xf bank_mask:0xf
    v_add_f32_dpp v28, v21, v28 quad_perm:[1,1,1,1] row_mask:0xf bank_mask:0xf
    v_add_f32_dpp v29, v23, v29 quad_perm:[3,3,3,3] row_mask:0xf bank_mask:0xf
    v_add_f32_dpp v30, v25, v30 quad_perm:[1,1,1,1] row_mask:0xf bank_mask:0xf
    v_add_f32_dpp v31, v27, v31 quad_perm:[3,3,3,3] row_mask:0xf bank_mask:0xf
    v_add_f32 v28, v28, v29
    v_cndmask_b32 v55, v55, v28, s[46:47]
    v_add_f32 v30, v30, v31
    v_cndmask_b32 v55, v55, v30, s[48:49]
    v_cvt_pk_bf16_f32 v55, v55, v55
    v_and_b32 v55, 0xffff0000, v55
    v_mul_f32 v55, 0x3db504f3, v55
    v_cvt_pk_bf16_f32 v55, v55, v55
    v_and_b32 v55, 0xffff0000, v55
    v_max_f32 v6, v6, v55
L_pad12:
    s_cmp_eq_u32 s51, 1
    s_cbranch_scc1 L_pad13
    s_waitcnt vmcnt(5)
    s_cbranch_vccnz L_w78
    s_waitcnt vmcnt(4)
L_w78:
    buffer_load_dwordx4 v[176:179], v1, s[8:11], s28 offen nt
    s_xor_b32 s28, s26, 0x48c400
    v_mfma_f32_16x16x32_bf16 v[20:23], v[104:107], v[8:11], 0
    v_mfma_f32_16x16x32_bf16 v[24:27], v[108:111], v[8:11], 0
    v_mov_b32_dpp v28, v12 quad_perm:[0,0,0,0] row_mask:0xf bank_mask:0xf
    v_mov_b32_dpp v29, v14 quad_perm:[2,2,2,2] row_mask:0xf bank_mask:0xf
    v_mov_b32_dpp v30, v16 quad_perm:[0,0,0,0] row_mask:0xf bank_mask:0xf
    v_mov_b32_dpp v31, v18 quad_perm:[2,2,2,2] row_mask:0xf bank_mask:0xf
    v_add_f32_dpp v28, v13, v28 quad_perm:[1,1,1,1] row_mask:0xf bank_mask:0xf
    v_add_f32_dpp v29, v15, v29 quad_perm:[3,3,3,3] row_mask:0xf bank_mask:0xf
    v_add_f32_dpp v30, v17, v30 quad_perm:[1,1,1,1] row_mask:0xf bank_mask:0xf
    v_add_f32_dpp v31, v19, v31 quad_perm:[3,3,3,3] row_mask:0xf bank_mask:0xf
    v_add_f32 v56, v28, v29
    v_add_f32 v30, v30, v31
    v_cndmask_b32 v56, v56, v30, s[44:45]
    s_waitcnt lgkmcnt(0)
    v_cmp_lt_i32 vcc, 3, v78
    v_mov_b32 v79, 39
    ds_write_b32 v76, v79 offset:16384
    ds_read_b32 v78, v77 offset:256
    s_waitcnt vmcnt(5)
    s_cbranch_vccnz L_w79
    s_waitcnt vmcnt(4)
L_w79:
    buffer_load_dwordx4 v[180:183], v1, s[8:11], s28 offen nt
    s_xor_b32 s28, s26, 0x40c800
    v_mfma_f32_16x16x32_bf16 v[12:15], v[112:115], v[8:11], 0
    v_mfma_f32_16x16x32_bf16 v[16:19], v[116:119], v[8:11], 0
    v_mov_b32_dpp v28, v20 quad_perm:[0,0,0,0] row_mask:0xf bank_mask:0xf
    v_mov_b32_dpp v29, v22 quad_perm:[2,2,2,2] row_mask:0xf bank_mask:0xf
    v_mov_b32_dpp v30, v24 quad_perm:[0,0,0,0] row_mask:0xf bank_mask:0xf
    v_mov_b32_dpp v31, v26 quad_perm:[2,2,2,2] row_mask:0xf bank_mask:0xf
    v_add_f32_dpp v28, v21, v28 quad_perm:[1,1,1,1] row_mask:0xf bank_mask:0xf
    v_add_f32_dpp v29, v23, v29 quad_perm:[3,3,3,3] row_mask:0xf bank_mask:0xf
    v_add_f32_dpp v30, v25, v30 quad_perm:[1,1,1,1] row_mask:0xf bank_mask:0xf
    v_add_f32_dpp v31, v27, v31 quad_perm:[3,3,3,3] row_mask:0xf bank_mask:0xf
    v_add_f32 v28, v28, v29
    v_cndmask_b32 v56, v56, v28, s[46:47]
    v_add_f32 v30, v30, v31
    v_cndmask_b32 v56, v56, v30, s[48:49]
    v_cvt_pk_bf16_f32 v56, v56, v56
    v_and_b32 v56, 0xffff0000, v56
    v_mul_f32 v56, 0x3db504f3, v56
    v_cvt_pk_bf16_f32 v56, v56, v56
    v_and_b32 v56, 0xffff0000, v56
    v_max_f32 v6, v6, v56
    s_waitcnt vmcnt(5)
    s_cbranch_vccnz L_w80
    s_waitcnt vmcnt(4)
L_w80:
    buffer_load_dwordx4 v[184:187], v1, s[8:11], s28 offen nt
    s_xor_b32 s28, s26, 0x48cc00
    v_mfma_f32_16x16x32_bf16 v[20:23], v[120:123], v[8:11], 0
    v_mfma_f32_16x16x32_bf16 v[24:27], v[124:127], v[8:11], 0
    v_mov_b32_dpp v28, v12 quad_perm:[0,0,0,0] row_mask:0xf bank_mask:0xf
    v_mov_b32_dpp v29, v14 quad_perm:[2,2,2,2] row_mask:0xf bank_mask:0xf
    v_mov_b32_dpp v30, v16 quad_perm:[0,0,0,0] row_mask:0xf bank_mask:0xf
    v_mov_b32_dpp v31, v18 quad_perm:[2,2,2,2] row_mask:0xf bank_mask:0xf
    v_add_f32_dpp v28, v13, v28 quad_perm:[1,1,1,1] row_mask:0xf bank_mask:0xf
    v_add_f32_dpp v29, v15, v29 quad_perm:[3,3,3,3] row_mask:0xf bank_mask:0xf
    v_add_f32_dpp v30, v17, v30 quad_perm:[1,1,1,1] row_mask:0xf bank_mask:0xf
    v_add_f32_dpp v31, v19, v31 quad_perm:[3,3,3,3] row_mask:0xf bank_mask:0xf
    v_add_f32 v57, v28, v29
    v_add_f32 v30, v30, v31
    v_cndmask_b32 v57, v57, v30, s[44:45]
    s_waitcnt lgkmcnt(0)
    v_cmp_lt_i32 vcc, 0, v78
    v_mov_b32 v79, 40
    ds_write_b32 v76, v79 offset:16384
    ds_read_b32 v78, v77 offset:256
    s_waitcnt vmcnt(5)
    s_cbranch_vccnz L_w81
    s_waitcnt vmcnt(4)
L_w81:
    buffer_load_dwordx4 v[188:191], v1, s[8:11], s28 offen nt
    s_xor_b32 s28, s26, 0x418000
    v_mfma_f32_16x16x32_bf16 v[12:15], v[128:131], v[8:11], 0
    v_mfma_f32_16x16x32_bf16 v[16:19], v[132:135], v[8:11], 0
    v_mov_b32_dpp v28, v20 quad_perm:[0,0,0,0] row_mask:0xf bank_mask:0xf
    v_mov_b32_dpp v29, v22 quad_perm:[2,2,2,2] row_mask:0xf bank_mask:0xf
    v_mov_b32_dpp v30, v24 quad_perm:[0,0,0,0] row_mask:0xf bank_mask:0xf
    v_mov_b32_dpp v31, v26 quad_perm:[2,2,2,2] row_mask:0xf bank_mask:0xf
    v_add_f32_dpp v28, v21, v28 quad_perm:[1,1,1,1] row_mask:0xf bank_mask:0xf
    v_add_f32_dpp v29, v23, v29 quad_perm:[3,3,3,3] row_mask:0xf bank_mask:0xf
    v_add_f32_dpp v30, v25, v30 quad_perm:[1,1,1,1] row_mask:0xf bank_mask:0xf
    v_add_f32_dpp v31, v27, v31 quad_perm:[3,3,3,3] row_mask:0xf bank_mask:0xf
    v_add_f32 v28, v28, v29
    v_cndmask_b32 v57, v57, v28, s[46:47]
    v_add_f32 v30, v30, v31
    v_cndmask_b32 v57, v57, v30, s[48:49]
    v_cvt_pk_bf16_f32 v57, v57, v57
    v_and_b32 v57, 0xffff0000, v57
    v_mul_f32 v57, 0x3db504f3, v57
    v_cvt_pk_bf16_f32 v57, v57, v57
    v_and_b32 v57, 0xffff0000, v57
    v_max_f32 v6, v6, v57
    s_waitcnt vmcnt(5)
    s_cbranch_vccnz L_w82
    s_waitcnt vmcnt(4)
L_w82:
    buffer_load_dwordx4 v[192:195], v1, s[8:11], s28 offen nt
    s_xor_b32 s28, s26, 0x498400
    v_mfma_f32_16x16x32_bf16 v[20:23], v[136:139], v[8:11], 0
    v_mfma_f32_16x16x32_bf16 v[24:27], v[140:143], v[8:11], 0
    v_mov_b32_dpp v28, v12 quad_perm:[0,0,0,0] row_mask:0xf bank_mask:0xf
    v_mov_b32_dpp v29, v14 quad_perm:[2,2,2,2] row_mask:0xf bank_mask:0xf
    v_mov_b32_dpp v30, v16 quad_perm:[0,0,0,0] row_mask:0xf bank_mask:0xf
    v_mov_b32_dpp v31, v18 quad_perm:[2,2,2,2] row_mask:0xf bank_mask:0xf
    v_add_f32_dpp v28, v13, v28 quad_perm:[1,1,1,1] row_mask:0xf bank_mask:0xf
    v_add_f32_dpp v29, v15, v29 quad_perm:[3,3,3,3] row_mask:0xf bank_mask:0xf
    v_add_f32_dpp v30, v17, v30 quad_perm:[1,1,1,1] row_mask:0xf bank_mask:0xf
    v_add_f32_dpp v31, v19, v31 quad_perm:[3,3,3,3] row_mask:0xf bank_mask:0xf
    v_add_f32 v58, v28, v29
    v_add_f32 v30, v30, v31
    v_cndmask_b32 v58, v58, v30, s[44:45]
    s_waitcnt lgkmcnt(0)
    v_cmp_lt_i32 vcc, 2, v78
    v_mov_b32 v79, 41
    ds_write_b32 v76, v79 offset:16384
    ds_read_b32 v78, v77 offset:256
    s_waitcnt vmcnt(5)
    s_cbranch_vccnz L_w83
    s_waitcnt vmcnt(4)
L_w83:
    buffer_load_dwordx4 v[196:199], v1, s[8:11], s28 offen nt
    s_xor_b32 s28, s26, 0x418800
    v_mfma_f32_16x16x32_bf16 v[12:15], v[144:147], v[8:11], 0
    v_mfma_f32_16x16x32_bf16 v[16:19], v[148:151], v[8:11], 0
    v_mov_b32_dpp v28, v20 quad_perm:[0,0,0,0] row_mask:0xf bank_mask:0xf
    v_mov_b32_dpp v29, v22 quad_perm:[2,2,2,2] row_mask:0xf bank_mask:0xf
    v_mov_b32_dpp v30, v24 quad_perm:[0,0,0,0] row_mask:0xf bank_mask:0xf
    v_mov_b32_dpp v31, v26 quad_perm:[2,2,2,2] row_mask:0xf bank_mask:0xf
    v_add_f32_dpp v28, v21, v28 quad_perm:[1,1,1,1] row_mask:0xf bank_mask:0xf
    v_add_f32_dpp v29, v23, v29 quad_perm:[3,3,3,3] row_mask:0xf bank_mask:0xf
    v_add_f32_dpp v30, v25, v30 quad_perm:[1,1,1,1] row_mask:0xf bank_mask:0xf
    v_add_f32_dpp v31, v27, v31 quad_perm:[3,3,3,3] row_mask:0xf bank_mask:0xf
    v_add_f32 v28, v28, v29
    v_cndmask_b32 v58, v58, v28, s[46:47]
    v_add_f32 v30, v30, v31
    v_cndmask_b32 v58, v58, v30, s[48:49]
    v_cvt_pk_bf16_f32 v58, v58, v58
    v_and_b32 v58, 0xffff0000, v58
    v_mul_f32 v58, 0x3db504f3, v58
    v_cvt_pk_bf16_f32 v58, v58, v58
    v_and_b32 v58, 0xffff0000, v58
    v_max_f32 v6, v6, v58
    s_waitcnt vmcnt(5)
    s_cbranch_vccnz L_w84
    s_waitcnt vmcnt(4)
L_w84:
    buffer_load_dwordx4 v[200:203], v1, s[8:11], s28 offen nt
    s_xor_b32 s28, s26, 0x498c00
    v_mfma_f32_16x16x32_bf16 v[20:23], v[152:155], v[8:11], 0
    v_mfma_f32_16x16x32_bf16 v[24:27], v[156:159], v[8:11], 0
    v_mov_b32_dpp v28, v12 quad_perm:[0,0,0,0] row_mask:0xf bank_mask:0xf
    v_mov_b32_dpp v29, v14 quad_perm:[2,2,2,2] row_mask:0xf bank_mask:0xf
    v_mov_b32_dpp v30, v16 quad_perm:[0,0,0,0] row_mask:0xf bank_mask:0xf
    v_mov_b32_dpp v31, v18 quad_perm:[2,2,2,2] row_mask:0xf bank_mask:0xf
L_pad13:
    s_cmp_eq_u32 s51, 1
    s_cbranch_scc1 L_pad14
    v_add_f32_dpp v28, v13, v28 quad_perm:[1,1,1,1] row_mask:0xf bank_mask:0xf
    v_add_f32_dpp v29, v15, v29 quad_perm:[3,3,3,3] row_mask:0xf bank_mask:0xf
    v_add_f32_dpp v30, v17, v30 quad_perm:[1,1,1,1] row_mask:0xf bank_mask:0xf
    v_add_f32_dpp v31, v19, v31 quad_perm:[3,3,3,3] row_mask:0xf bank_mask:0xf
    v_add_f32 v59, v28, v29
    v_add_f32 v30, v30, v31
    v_cndmask_b32 v59, v59, v30, s[44:45]
    s_waitcnt lgkmcnt(0)
    v_cmp_lt_i32 vcc, 1, v78
    v_mov_b32 v79, 42
    ds_write_b32 v76, v79 offset:16384
    ds_read_b32 v78, v77 offset:256
    s_waitcnt vmcnt(5)
    s_cbranch_vccnz L_w85
    s_waitcnt vmcnt(4)
L_w85:
    buffer_load_dwordx4 v[204:207], v1, s[8:11], s28 offen nt
    s_xor_b32 s28, s26, 0x41c000
    v_mfma_f32_16x16x32_bf16 v[12:15], v[160:163], v[8:11], 0
    v_mfma_f32_16x16x32_bf16 v[16:19], v[164:167], v[8:11], 0
    v_mov_b32_dpp v28, v20 quad_perm:[0,0,0,0] row_mask:0xf bank_mask:0xf
    v_mov_b32_dpp v29, v22 quad_perm:[2,2,2,2] row_mask:0xf bank_mask:0xf
    v_mov_b32_dpp v30, v24 quad_perm:[0,0,0,0] row_mask:0xf bank_mask:0xf
    v_mov_b32_dpp v31, v26 quad_perm:[2,2,2,2] row_mask:0xf bank_mask:0xf
    v_add_f32_dpp v28, v21, v28 quad_perm:[1,1,1,1] row_mask:0xf bank_mask:0xf
    v_add_f32_dpp v29, v23, v29 quad_perm:[3,3,3,3] row_mask:0xf bank_mask:0xf
    v_add_f32_dpp v30, v25, v30 quad_perm:[1,1,1,1] row_mask:0xf bank_mask:0xf
    v_add_f32_dpp v31, v27, v31 quad_perm:[3,3,3,3] row_mask:0xf bank_mask:0xf
    v_add_f32 v28, v28, v29
    v_cndmask_b32 v59, v59, v28, s[46:47]
    v_add_f32 v30, v30, v31
    v_cndmask_b32 v59, v59, v30, s[48:49]
    v_cvt_pk_bf16_f32 v59, v59, v59
    v_and_b32 v59, 0xffff0000, v59
    v_mul_f32 v59, 0x3db504f3, v59
    v_cvt_pk_bf16_f32 v59, v59, v59
    v_and_b32 v59, 0xffff0000, v59
    v_max_f32 v6, v6, v59
    s_waitcnt vmcnt(5)
    s_cbranch_vccnz L_w86
    s_waitcnt vmcnt(4)
L_w86:
    buffer_load_dwordx4 v[208:211], v1, s[8:11], s28 offen nt
    s_xor_b32 s28, s26, 0x49c400
    v_mfma_f32_16x16x32_bf16 v[20:23], v[168:171], v[8:11], 0
    v_mfma_f32_16x16x32_bf16 v[24:27], v[172:175], v[8:11], 0
    v_mov_b32_dpp v28, v12 quad_perm:[0,0,0,0] row_mask:0xf bank_mask:0xf
    v_mov_b32_dpp v29, v14 quad_perm:[2,2,2,2] row_mask:0xf bank_mask:0xf
    v_mov_b32_dpp v30, v16 quad_perm:[0,0,0,0] row_mask:0xf bank_mask:0xf
    v_mov_b32_dpp v31, v18 quad_perm:[2,2,2,2] row_mask:0xf bank_mask:0xf
    v_add_f32_dpp v28, v13, v28 quad_perm:[1,1,1,1] row_mask:0xf bank_mask:0xf
    v_add_f32_dpp v29, v15, v29 quad_perm:[3,3,3,3] row_mask:0xf bank_mask:0xf
    v_add_f32_dpp v30, v17, v30 quad_perm:[1,1,1,1] row_mask:0xf bank_mask:0xf
    v_add_f32_dpp v31, v19, v31 quad_perm:[3,3,3,3] row_mask:0xf bank_mask:0xf
    v_add_f32 v60, v28, v29
    v_add_f32 v30, v30, v31
    v_cndmask_b32 v60, v60, v30, s[44:45]
    s_waitcnt lgkmcnt(0)
    v_cmp_lt_i32 vcc, 3, v78
    v_mov_b32 v79, 43
    ds_write_b32 v76, v79 offset:16384
    ds_read_b32 v78, v77 offset:256
    s_waitcnt vmcnt(5)
    s_cbranch_vccnz L_w87
    s_waitcnt vmcnt(4)
L_w87:
    buffer_load_dwordx4 v[212:215], v1, s[8:11], s28 offen nt
    s_xor_b32 s28, s26, 0x41c800
    v_mfma_f32_16x16x32_bf16 v[12:15], v[176:179], v[8:11], 0
    v_mfma_f32_16x16x32_bf16 v[16:19], v[180:183], v[8:11], 0
    v_mov_b32_dpp v28, v20 quad_perm:[0,0,0,0] row_mask:0xf bank_mask:0xf
    v_mov_b32_dpp v29, v22 quad_perm:[2,2,2,2] row_mask:0xf bank_mask:0xf
    v_mov_b32_dpp v30, v24 quad_perm:[0,0,0,0] row_mask:0xf bank_mask:0xf
    v_mov_b32_dpp v31, v26 quad_perm:[2,2,2,2] row_mask:0xf bank_mask:0xf
    v_add_f32_dpp v28, v21, v28 quad_perm:[1,1,1,1] row_mask:0xf bank_mask:0xf
    v_add_f32_dpp v29, v23, v29 quad_perm:[3,3,3,3] row_mask:0xf bank_mask:0xf
    v_add_f32_dpp v30, v25, v30 quad_perm:[1,1,1,1] row_mask:0xf bank_mask:0xf
    v_add_f32_dpp v31, v27, v31 quad_perm:[3,3,3,3] row_mask:0xf bank_mask:0xf
    v_add_f32 v28, v28, v29
    v_cndmask_b32 v60, v60, v28, s[46:47]
    v_add_f32 v30, v30, v31
    v_cndmask_b32 v60, v60, v30, s[48:49]
    v_cvt_pk_bf16_f32 v60, v60, v60
    v_and_b32 v60, 0xffff0000, v60
    v_mul_f32 v60, 0x3db504f3, v60
    v_cvt_pk_bf16_f32 v60, v60, v60
    v_and_b32 v60, 0xffff0000, v60
    v_max_f32 v6, v6, v60
    s_waitcnt vmcnt(5)
    s_cbranch_vccnz L_w88
    s_waitcnt vmcnt(4)
L_w88:
    buffer_load_dwordx4 v[216:219], v1, s[8:11], s28 offen nt
    s_xor_b32 s28, s26, 0x49cc00
    v_mfma_f32_16x16x32_bf16 v[20:23], v[184:187], v[8:11], 0
    v_mfma_f32_16x16x32_bf16 v[24:27], v[188:191], v[8:11], 0
    v_mov_b32_dpp v28, v12 quad_perm:[0,0,0,0] row_mask:0xf bank_mask:0xf
    v_mov_b32_dpp v29, v14 quad_perm:[2,2,2,2] row_mask:0xf bank_mask:0xf
    v_mov_b32_dpp v30, v16 quad_perm:[0,0,0,0] row_mask:0xf bank_mask:0xf
    v_mov_b32_dpp v31, v18 quad_perm:[2,2,2,2] row_mask:0xf bank_mask:0xf
    v_add_f32_dpp v28, v13, v28 quad_perm:[1,1,1,1] row_mask:0xf bank_mask:0xf
    v_add_f32_dpp v29, v15, v29 quad_perm:[3,3,3,3] row_mask:0xf bank_mask:0xf
    v_add_f32_dpp v30, v17, v30 quad_perm:[1,1,1,1] row_mask:0xf bank_mask:0xf
    v_add_f32_dpp v31, v19, v31 quad_perm:[3,3,3,3] row_mask:0xf bank_mask:0xf
    v_add_f32 v61, v28, v29
    v_add_f32 v30, v30, v31
    v_cndmask_b32 v61, v61, v30, s[44:45]
    s_waitcnt lgkmcnt(0)
    v_cmp_lt_i32 vcc, 0, v78
    v_mov_b32 v79, 44
    ds_write_b32 v76, v79 offset:16384
    ds_read_b32 v78, v77 offset:256
    s_waitcnt vmcnt(5)
    s_cbranch_vccnz L_w89
    s_waitcnt vmcnt(4)
L_w89:
    buffer_load_dwordx4 v[220:223], v1, s[8:11], s28 offen nt
    s_xor_b32 s28, s26, 0x428400
    v_mfma_f32_16x16x32_bf16 v[12:15], v[192:195], v[8:11], 0
    v_mfma_f32_16x16x32_bf16 v[16:19], v[196:199], v[8:11], 0
    v_mov_b32_dpp v28, v20 quad_perm:[0,0,0,0] row_mask:0xf bank_mask:0xf
    v_mov_b32_dpp v29, v22 quad_perm:[2,2,2,2] row_mask:0xf bank_mask:0xf
    v_mov_b32_dpp v30, v24 quad_perm:[0,0,0,0] row_mask:0xf bank_mask:0xf
    v_mov_b32_dpp v31, v26 quad_perm:[2,2,2,2] row_mask:0xf bank_mask:0xf
    v_add_f32_dpp v28, v21, v28 quad_perm:[1,1,1,1] row_mask:0xf bank_mask:0xf
    v_add_f32_dpp v29, v23, v29 quad_perm:[3,3,3,3] row_mask:0xf bank_mask:0xf
    v_add_f32_dpp v30, v25, v30 quad_perm:[1,1,1,1] row_mask:0xf bank_mask:0xf
    v_add_f32_dpp v31, v27, v31 quad_perm:[3,3,3,3] row_mask:0xf bank_mask:0xf
    v_add_f32 v28, v28, v29
    v_cndmask_b32 v61, v61, v28, s[46:47]
    v_add_f32 v30, v30, v31
    v_cndmask_b32 v61, v61, v30, s[48:49]
    v_cvt_pk_bf16_f32 v61, v61, v61
    v_and_b32 v61, 0xffff0000, v61
    v_mul_f32 v61, 0x3db504f3, v61
    v_cvt_pk_bf16_f32 v61, v61, v61
    v_and_b32 v61, 0xffff0000, v61
    v_max_f32 v6, v6, v61
    s_waitcnt vmcnt(5)
    s_cbranch_vccnz L_w90
    s_waitcnt vmcnt(4)
L_w90:
    buffer_load_dwordx4 v[224:227], v1, s[8:11], s28 offen nt
    s_xor_b32 s28, s26, 0x4a8000
    v_mfma_f32_16x16x32_bf16 v[20:23], v[200:203], v[8:11], 0
    v_mov_b32_dpp v28, v12 quad_perm:[0,0,0,0] row_mask:0xf bank_mask:0xf
    v_mov_b32_dpp v29, v14 quad_perm:[2,2,2,2] row_mask:0xf bank_mask:0xf
    v_mov_b32_dpp v30, v16 quad_perm:[0,0,0,0] row_mask:0xf bank_mask:0xf
    v_mov_b32_dpp v31, v18 quad_perm:[2,2,2,2] row_mask:0xf bank_mask:0xf
L_pad14:
    s_cmp_eq_u32 s51, 1
    s_cbranch_scc1 L_pad15
    v_add_f32_dpp v28, v13, v28 quad_perm:[1,1,1,1] row_mask:0xf bank_mask:0xf
    v_add_f32_dpp v29, v15, v29 quad_perm:[3,3,3,3] row_mask:0xf bank_mask:0xf
    v_add_f32_dpp v30, v17, v30 quad_perm:[1,1,1,1] row_mask:0xf bank_mask:0xf
    v_add_f32_dpp v31, v19, v31 quad_perm:[3,3,3,3] row_mask:0xf bank_mask:0xf
    v_add_f32 v62, v28, v29
    v_add_f32 v30, v30, v31
    v_cndmask_b32 v62, v62, v30, s[44:45]
    s_waitcnt lgkmcnt(0)
    v_cmp_lt_i32 vcc, 2, v78
    v_mov_b32 v79, 45
    ds_write_b32 v76, v79 offset:16384
    ds_read_b32 v78, v77 offset:256
    s_waitcnt vmcnt(5)
    s_cbranch_vccnz L_w91
    s_waitcnt vmcnt(4)
L_w91:
    buffer_load_dwordx4 v[228:231], v1, s[8:11], s28 offen nt
    s_xor_b32 s28, s26, 0x428c00
    v_mfma_f32_16x16x32_bf16 v[24:27], v[204:207], v[8:11], 0
    v_mov_b32_dpp v28, v20 quad_perm:[0,0,0,0] row_mask:0xf bank_mask:0xf
    v_mov_b32_dpp v29, v22 quad_perm:[2,2,2,2] row_mask:0xf bank_mask:0xf
    s_nop 0
    v_add_f32_dpp v28, v21, v28 quad_perm:[1,1,1,1] row_mask:0xf bank_mask:0xf
    v_add_f32_dpp v29, v23, v29 quad_perm:[3,3,3,3] row_mask:0xf bank_mask:0xf
    v_add_f32 v28, v28, v29
    v_cndmask_b32 v62, v62, v28, s[46:47]
    s_waitcnt vmcnt(5)
    s_cbranch_vccnz L_w92
    s_waitcnt vmcnt(4)
L_w92:
    buffer_load_dwordx4 v[232:235], v1, s[8:11], s28 offen nt
    s_xor_b32 s28, s26, 0x4a8800
    v_mfma_f32_16x16x32_bf16 v[12:15], v[208:211], v[8:11], 0
    v_mov_b32_dpp v28, v24 quad_perm:[0,0,0,0] row_mask:0xf bank_mask:0xf
    v_mov_b32_dpp v29, v26 quad_perm:[2,2,2,2] row_mask:0xf bank_mask:0xf
    s_nop 0
    v_add_f32_dpp v28, v25, v28 quad_perm:[1,1,1,1] row_mask:0xf bank_mask:0xf
    v_add_f32_dpp v29, v27, v29 quad_perm:[3,3,3,3] row_mask:0xf bank_mask:0xf
    v_add_f32 v28, v28, v29
    v_cndmask_b32 v62, v62, v28, s[48:49]
    v_cvt_pk_bf16_f32 v62, v62, v62
    v_and_b32 v62, 0xffff0000, v62
    v_mul_f32 v62, 0x3db504f3, v62
    v_cvt_pk_bf16_f32 v62, v62, v62
    v_and_b32 v62, 0xffff0000, v62
    v_max_f32 v6, v6, v62
    s_waitcnt lgkmcnt(0)
    v_cmp_lt_i32 vcc, 1, v78
    v_mov_b32 v79, 46
    ds_write_b32 v76, v79 offset:16384
    ds_read_b32 v78, v77 offset:256
    s_waitcnt vmcnt(5)
    s_cbranch_vccnz L_w93
    s_waitcnt vmcnt(4)
L_w93:
    buffer_load_dwordx4 v[236:239], v1, s[8:11], s28 offen nt
    s_xor_b32 s28, s26, 0x42c400
    v_mfma_f32_16x16x32_bf16 v[16:19], v[212:215], v[8:11], 0
    v_mov_b32_dpp v28, v12 quad_perm:[0,0,0,0] row_mask:0xf bank_mask:0xf
    v_mov_b32_dpp v29, v14 quad_perm:[2,2,2,2] row_mask:0xf bank_mask:0xf
    s_nop 0
    v_add_f32_dpp v28, v13, v28 quad_perm:[1,1,1,1] row_mask:0xf bank_mask:0xf
    v_add_f32_dpp v29, v15, v29 quad_perm:[3,3,3,3] row_mask:0xf bank_mask:0xf
    v_add_f32 v63, v28, v29
    s_waitcnt vmcnt(5)
    s_cbranch_vccnz L_w94
    s_waitcnt vmcnt(4)
L_w94:
    buffer_load_dwordx4 v[240:243], v1, s[8:11], s28 offen nt
    s_xor_b32 s28, s26, 0x4ac000
    v_mfma_f32_16x16x32_bf16 v[20:23], v[216:219], v[8:11], 0
    v_mov_b32_dpp v28, v16 quad_perm:[0,0,0,0] row_mask:0xf bank_mask:0xf
    v_mov_b32_dpp v29, v18 quad_perm:[2,2,2,2] row_mask:0xf bank_mask:0xf
    s_nop 0
    v_add_f32_dpp v28, v17, v28 quad_perm:[1,1,1,1] row_mask:0xf bank_mask:0xf
    v_add_f32_dpp v29, v19, v29 quad_perm:[3,3,3,3] row_mask:0xf bank_mask:0xf
    v_add_f32 v28, v28, v29
    v_cndmask_b32 v63, v63, v28, s[44:45]
    s_waitcnt lgkmcnt(0)
    v_cmp_lt_i32 vcc, 3, v78
    v_mov_b32 v79, 47
    ds_write_b32 v76, v79 offset:16384
    ds_read_b32 v78, v77 offset:256
    s_waitcnt vmcnt(5)
    s_cbranch_vccnz L_w95
    s_waitcnt vmcnt(4)
L_w95:
    buffer_load_dwordx4 v[244:247], v1, s[8:11], s28 offen nt
    s_xor_b32 s28, s26, 0x42cc00
    v_mfma_f32_16x16x32_bf16 v[24:27], v[220:223], v[8:11], 0
    v_mov_b32_dpp v28, v20 quad_perm:[0,0,0,0] row_mask:0xf bank_mask:0xf
    v_mov_b32_dpp v29, v22 quad_perm:[2,2,2,2] row_mask:0xf bank_mask:0xf
    s_nop 0
    v_add_f32_dpp v28, v21, v28 quad_perm:[1,1,1,1] row_mask:0xf bank_mask:0xf
    v_add_f32_dpp v29, v23, v29 quad_perm:[3,3,3,3] row_mask:0xf bank_mask:0xf
    v_add_f32 v28, v28, v29
    v_cndmask_b32 v63, v63, v28, s[46:47]
    s_waitcnt vmcnt(5)
    s_cbranch_vccnz L_w96
    s_waitcnt vmcnt(4)
L_w96:
    buffer_load_dwordx4 v[248:251], v1, s[8:11], s28 offen nt
    s_xor_b32 s28, s26, 0x4ac800
    v_mfma_f32_16x16x32_bf16 v[12:15], v[224:227], v[8:11], 0
    v_mov_b32_dpp v28, v24 quad_perm:[0,0,0,0] row_mask:0xf bank_mask:0xf
    v_mov_b32_dpp v29, v26 quad_perm:[2,2,2,2] row_mask:0xf bank_mask:0xf
    s_nop 0
    v_add_f32_dpp v28, v25, v28 quad_perm:[1,1,1,1] row_mask:0xf bank_mask:0xf
    v_add_f32_dpp v29, v27, v29 quad_perm:[3,3,3,3] row_mask:0xf bank_mask:0xf
    v_add_f32 v28, v28, v29
    v_cndmask_b32 v63, v63, v28, s[48:49]
    v_cvt_pk_bf16_f32 v63, v63, v63
    v_and_b32 v63, 0xffff0000, v63
    v_mul_f32 v63, 0x3db504f3, v63
    v_cvt_pk_bf16_f32 v63, v63, v63
    v_and_b32 v63, 0xffff0000, v63
    v_max_f32 v6, v6, v63
    s_waitcnt lgkmcnt(0)
    v_cmp_lt_i32 vcc, 0, v78
    v_mov_b32 v79, 48
    ds_write_b32 v76, v79 offset:16384
    ds_read_b32 v78, v77 offset:256
    s_waitcnt vmcnt(5)
    s_cbranch_vccnz L_w97
    s_waitcnt vmcnt(4)
L_w97:
    buffer_load_dwordx4 v[252:255], v1, s[8:11], s28 offen nt
    s_xor_b32 s28, s26, 0x438400
    v_mfma_f32_16x16x32_bf16 v[16:19], v[228:231], v[8:11], 0
    v_mov_b32_dpp v28, v12 quad_perm:[0,0,0,0] row_mask:0xf bank_mask:0xf
    v_mov_b32_dpp v29, v14 quad_perm:[2,2,2,2] row_mask:0xf bank_mask:0xf
    s_nop 0
    v_add_f32_dpp v28, v13, v28 quad_perm:[1,1,1,1] row_mask:0xf bank_mask:0xf
    v_add_f32_dpp v29, v15, v29 quad_perm:[3,3,3,3] row_mask:0xf bank_mask:0xf
    v_add_f32 v64, v28, v29
    s_waitcnt vmcnt(5)
    s_cbranch_vccnz L_w98
    s_waitcnt vmcnt(4)
L_w98:
    buffer_load_dwordx4 v[80:83], v1, s[8:11], s28 offen nt
    s_xor_b32 s28, s26, 0x4b8000
    v_mfma_f32_16x16x32_bf16 v[20:23], v[232:235], v[8:11], 0
    v_mov_b32_dpp v28, v16 quad_perm:[0,0,0,0] row_mask:0xf bank_mask:0xf
    v_mov_b32_dpp v29, v18 quad_perm:[2,2,2,2] row_mask:0xf bank_mask:0xf
    s_nop 0
    v_add_f32_dpp v28, v17, v28 quad_perm:[1,1,1,1] row_mask:0xf bank_mask:0xf
    v_add_f32_dpp v29, v19, v29 quad_perm:[3,3,3,3] row_mask:0xf bank_mask:0xf
    v_add_f32 v28, v28, v29
    v_cndmask_b32 v64, v64, v28, s[44:45]
    s_waitcnt lgkmcnt(0)
    v_cmp_lt_i32 vcc, 2, v78
    v_mov_b32 v79, 49
    ds_write_b32 v76, v79 offset:16384
    ds_read_b32 v78, v77 offset:256
    s_waitcnt vmcnt(5)
    s_cbranch_vccnz L_w99
    s_waitcnt vmcnt(4)
L_w99:
    buffer_load_dwordx4 v[84:87], v1, s[8:11], s28 offen nt
    s_xor_b32 s28, s26, 0x438c00
    v_mfma_f32_16x16x32_bf16 v[24:27], v[236:239], v[8:11], 0
    v_mov_b32_dpp v28, v20 quad_perm:[0,0,0,0] row_mask:0xf bank_mask:0xf
    v_mov_b32_dpp v29, v22 quad_perm:[2,2,2,2] row_mask:0xf bank_mask:0xf
    s_nop 0
    v_add_f32_dpp v28, v21, v28 quad_perm:[1,1,1,1] row_mask:0xf bank_mask:0xf
    v_add_f32_dpp v29, v23, v29 quad_perm:[3,3,3,3] row_mask:0xf bank_mask:0xf
    v_add_f32 v28, v28, v29
    v_cndmask_b32 v64, v64, v28, s[46:47]
L_pad15:
    s_cmp_eq_u32 s51, 1
    s_cbranch_scc1 L_pad16
    s_waitcnt vmcnt(5)
    s_cbranch_vccnz L_w100
    s_waitcnt vmcnt(4)
L_w100:
    buffer_load_dwordx4 v[88:91], v1, s[8:11], s28 offen nt
    s_xor_b32 s28, s26, 0x4b8800
    v_mfma_f32_16x16x32_bf16 v[12:15], v[240:243], v[8:11], 0
    v_mov_b32_dpp v28, v24 quad_perm:[0,0,0,0] row_mask:0xf bank_mask:0xf
    v_mov_b32_dpp v29, v26 quad_perm:[2,2,2,2] row_mask:0xf bank_mask:0xf
    s_nop 0
    v_add_f32_dpp v28, v25, v28 quad_perm:[1,1,1,1] row_mask:0xf bank_mask:0xf
    v_add_f32_dpp v29, v27, v29 quad_perm:[3,3,3,3] row_mask:0xf bank_mask:0xf
    v_add_f32 v28, v28, v29
    v_cndmask_b32 v64, v64, v28, s[48:49]
    v_cvt_pk_bf16_f32 v64, v64, v64
    v_and_b32 v64, 0xffff0000, v64
    v_mul_f32 v64, 0x3db504f3, v64
    v_cvt_pk_bf16_f32 v64, v64, v64
    v_and_b32 v64, 0xffff0000, v64
    v_max_f32 v6, v6, v64
    s_waitcnt lgkmcnt(0)
    v_cmp_lt_i32 vcc, 1, v78
    v_mov_b32 v79, 50
    ds_write_b32 v76, v79 offset:16384
    ds_read_b32 v78, v77 offset:256
    s_waitcnt vmcnt(5)
    s_cbranch_vccnz L_w101
    s_waitcnt vmcnt(4)
L_w101:
    buffer_load_dwordx4 v[92:95], v1, s[8:11], s28 offen nt
    s_xor_b32 s28, s26, 0x43c400
    v_mfma_f32_16x16x32_bf16 v[16:19], v[244:247], v[8:11], 0
    v_mov_b32_dpp v28, v12 quad_perm:[0,0,0,0] row_mask:0xf bank_mask:0xf
    v_mov_b32_dpp v29, v14 quad_perm:[2,2,2,2] row_mask:0xf bank_mask:0xf
    s_nop 0
    v_add_f32_dpp v28, v13, v28 quad_perm:[1,1,1,1] row_mask:0xf bank_mask:0xf
    v_add_f32_dpp v29, v15, v29 quad_perm:[3,3,3,3] row_mask:0xf bank_mask:0xf
    v_add_f32 v65, v28, v29
    s_waitcnt vmcnt(5)
    s_cbranch_vccnz L_w102
    s_waitcnt vmcnt(4)
L_w102:
    buffer_load_dwordx4 v[96:99], v1, s[8:11], s28 offen nt
    s_xor_b32 s28, s26, 0x4bc000
    v_mfma_f32_16x16x32_bf16 v[20:23], v[248:251], v[8:11], 0
    v_mov_b32_dpp v28, v16 quad_perm:[0,0,0,0] row_mask:0xf bank_mask:0xf
    v_mov_b32_dpp v29, v18 quad_perm:[2,2,2,2] row_mask:0xf bank_mask:0xf
    s_nop 0
    v_add_f32_dpp v28, v17, v28 quad_perm:[1,1,1,1] row_mask:0xf bank_mask:0xf
    v_add_f32_dpp v29, v19, v29 quad_perm:[3,3,3,3] row_mask:0xf bank_mask:0xf
    v_add_f32 v28, v28, v29
    v_cndmask_b32 v65, v65, v28, s[44:45]
    s_waitcnt lgkmcnt(0)
    v_cmp_lt_i32 vcc, 3, v78
    v_mov_b32 v79, 51
    ds_write_b32 v76, v79 offset:16384
    ds_read_b32 v78, v77 offset:256
    s_waitcnt vmcnt(5)
    s_cbranch_vccnz L_w103
    s_waitcnt vmcnt(4)
L_w103:
    buffer_load_dwordx4 v[100:103], v1, s[8:11], s28 offen nt
    s_xor_b32 s28, s26, 0x43cc00
    v_mfma_f32_16x16x32_bf16 v[24:27], v[252:255], v[8:11], 0
    v_mov_b32_dpp v28, v20 quad_perm:[0,0,0,0] row_mask:0xf bank_mask:0xf
    v_mov_b32_dpp v29, v22 quad_perm:[2,2,2,2] row_mask:0xf bank_mask:0xf
    s_nop 0
    v_add_f32_dpp v28, v21, v28 quad_perm:[1,1,1,1] row_mask:0xf bank_mask:0xf
    v_add_f32_dpp v29, v23, v29 quad_perm:[3,3,3,3] row_mask:0xf bank_mask:0xf
    v_add_f32 v28, v28, v29
    v_cndmask_b32 v65, v65, v28, s[46:47]
    s_waitcnt vmcnt(5)
    s_cbranch_vccnz L_w104
    s_waitcnt vmcnt(4)
L_w104:
    buffer_load_dwordx4 v[104:107], v1, s[8:11], s28 offen nt
    s_xor_b32 s28, s26, 0x4bc800
    v_mfma_f32_16x16x32_bf16 v[12:15], v[80:83], v[8:11], 0
    v_mov_b32_dpp v28, v24 quad_perm:[0,0,0,0] row_mask:0xf bank_mask:0xf
    v_mov_b32_dpp v29, v26 quad_perm:[2,2,2,2] row_mask:0xf bank_mask:0xf
    s_nop 0
    v_add_f32_dpp v28, v25, v28 quad_perm:[1,1,1,1] row_mask:0xf bank_mask:0xf
    v_add_f32_dpp v29, v27, v29 quad_perm:[3,3,3,3] row_mask:0xf bank_mask:0xf
    v_add_f32 v28, v28, v29
    v_cndmask_b32 v65, v65, v28, s[48:49]
    v_cvt_pk_bf16_f32 v65, v65, v65
    v_and_b32 v65, 0xffff0000, v65
    v_mul_f32 v65, 0x3db504f3, v65
    v_cvt_pk_bf16_f32 v65, v65, v65
    v_and_b32 v65, 0xffff0000, v65
    v_max_f32 v6, v6, v65
    s_waitcnt lgkmcnt(0)
    v_cmp_lt_i32 vcc, 0, v78
    v_mov_b32 v79, 52
    ds_write_b32 v76, v79 offset:16384
    ds_read_b32 v78, v77 offset:256
    s_waitcnt vmcnt(5)
    s_cbranch_vccnz L_w105
    s_waitcnt vmcnt(4)
L_w105:
    buffer_load_dwordx4 v[108:111], v1, s[8:11], s28 offen nt
    s_xor_b32 s28, s26, 0x509000
    v_mfma_f32_16x16x32_bf16 v[16:19], v[84:87], v[8:11], 0
    v_mov_b32_dpp v28, v12 quad_perm:[0,0,0,0] row_mask:0xf bank_mask:0xf
    v_mov_b32_dpp v29, v14 quad_perm:[2,2,2,2] row_mask:0xf bank_mask:0xf
    s_nop 0
    v_add_f32_dpp v28, v13, v28 quad_perm:[1,1,1,1] row_mask:0xf bank_mask:0xf
    v_add_f32_dpp v29, v15, v29 quad_perm:[3,3,3,3] row_mask:0xf bank_mask:0xf
    v_add_f32 v66, v28, v29
    s_waitcnt vmcnt(5)
    s_cbranch_vccnz L_w106
    s_waitcnt vmcnt(4)
L_w106:
    buffer_load_dwordx4 v[112:115], v1, s[8:11], s28 offen nt
    s_xor_b32 s28, s26, 0x589400
    v_mfma_f32_16x16x32_bf16 v[20:23], v[88:91], v[8:11], 0
    v_mov_b32_dpp v28, v16 quad_perm:[0,0,0,0] row_mask:0xf bank_mask:0xf
    v_mov_b32_dpp v29, v18 quad_perm:[2,2,2,2] row_mask:0xf bank_mask:0xf
    s_nop 0
    v_add_f32_dpp v28, v17, v28 quad_perm:[1,1,1,1] row_mask:0xf bank_mask:0xf
    v_add_f32_dpp v29, v19, v29 quad_perm:[3,3,3,3] row_mask:0xf bank_mask:0xf
    v_add_f32 v28, v28, v29
    v_cndmask_b32 v66, v66, v28, s[44:45]
    s_waitcnt lgkmcnt(0)
    v_cmp_lt_i32 vcc, 2, v78
    v_mov_b32 v79, 53
    ds_write_b32 v76, v79 offset:16384
    ds_read_b32 v78, v77 offset:256
    s_waitcnt vmcnt(5)
    s_cbranch_vccnz L_w107
    s_waitcnt vmcnt(4)
L_w107:
    buffer_load_dwordx4 v[116:119], v1, s[8:11], s28 offen nt
    s_xor_b32 s28, s26, 0x509800
    v_mfma_f32_16x16x32_bf16 v[24:27], v[92:95], v[8:11], 0
    v_mov_b32_dpp v28, v20 quad_perm:[0,0,0,0] row_mask:0xf bank_mask:0xf
    v_mov_b32_dpp v29, v22 quad_perm:[2,2,2,2] row_mask:0xf bank_mask:0xf
    s_nop 0
    v_add_f32_dpp v28, v21, v28 quad_perm:[1,1,1,1] row_mask:0xf bank_mask:0xf
    v_add_f32_dpp v29, v23, v29 quad_perm:[3,3,3,3] row_mask:0xf bank_mask:0xf
    v_add_f32 v28, v28, v29
    v_cndmask_b32 v66, v66, v28, s[46:47]
    s_waitcnt vmcnt(5)
    s_cbranch_vccnz L_w108
    s_waitcnt vmcnt(4)
L_w108:
    buffer_load_dwordx4 v[120:123], v1, s[8:11], s28 offen nt
    s_xor_b32 s28, s26, 0x589c00
    v_mfma_f32_16x16x32_bf16 v[12:15], v[96:99], v[8:11], 0
    v_mov_b32_dpp v28, v24 quad_perm:[0,0,0,0] row_mask:0xf bank_mask:0xf
    v_mov_b32_dpp v29, v26 quad_perm:[2,2,2,2] row_mask:0xf bank_mask:0xf
    s_nop 0
    v_add_f32_dpp v28, v25, v28 quad_perm:[1,1,1,1] row_mask:0xf bank_mask:0xf
    v_add_f32_dpp v29, v27, v29 quad_perm:[3,3,3,3] row_mask:0xf bank_mask:0xf
    v_add_f32 v28, v28, v29
    v_cndmask_b32 v66, v66, v28, s[48:49]
    v_cvt_pk_bf16_f32 v66, v66, v66
    v_and_b32 v66, 0xffff0000, v66
    v_mul_f32 v66, 0x3db504f3, v66
    v_cvt_pk_bf16_f32 v66, v66, v66
    v_and_b32 v66, 0xffff0000, v66
    v_max_f32 v6, v6, v66
    s_waitcnt lgkmcnt(0)
    v_cmp_lt_i32 vcc, 1, v78
    v_mov_b32 v79, 54
    ds_write_b32 v76, v79 offset:16384
    ds_read_b32 v78, v77 offset:256
L_pad16:
    s_cmp_eq_u32 s51, 1
    s_cbranch_scc1 L_pad17
    s_waitcnt vmcnt(5)
    s_cbranch_vccnz L_w109
    s_waitcnt vmcnt(4)
L_w109:
    buffer_load_dwordx4 v[124:127], v1, s[8:11], s28 offen nt
    s_xor_b32 s28, s26, 0x50d000
    v_mfma_f32_16x16x32_bf16 v[16:19], v[100:103], v[8:11], 0
    v_mov_b32_dpp v28, v12 quad_perm:[0,0,0,0] row_mask:0xf bank_mask:0xf
    v_mov_b32_dpp v29, v14 quad_perm:[2,2,2,2] row_mask:0xf bank_mask:0xf
    s_nop 0
    v_add_f32_dpp v28, v13, v28 quad_perm:[1,1,1,1] row_mask:0xf bank_mask:0xf
    v_add_f32_dpp v29, v15, v29 quad_perm:[3,3,3,3] row_mask:0xf bank_mask:0xf
    v_add_f32 v67, v28, v29
    s_waitcnt vmcnt(5)
    s_cbranch_vccnz L_w110
    s_waitcnt vmcnt(4)
L_w110:
    buffer_load_dwordx4 v[128:131], v1, s[8:11], s28 offen nt
    s_xor_b32 s28, s26, 0x58d400
    v_mfma_f32_16x16x32_bf16 v[20:23], v[104:107], v[8:11], 0
    v_mov_b32_dpp v28, v16 quad_perm:[0,0,0,0] row_mask:0xf bank_mask:0xf
    v_mov_b32_dpp v29, v18 quad_perm:[2,2,2,2] row_mask:0xf bank_mask:0xf
    s_nop 0
    v_add_f32_dpp v28, v17, v28 quad_perm:[1,1,1,1] row_mask:0xf bank_mask:0xf
    v_add_f32_dpp v29, v19, v29 quad_perm:[3,3,3,3] row_mask:0xf bank_mask:0xf
    v_add_f32 v28, v28, v29
    v_cndmask_b32 v67, v67, v28, s[44:45]
    s_waitcnt lgkmcnt(0)
    v_cmp_lt_i32 vcc, 3, v78
    v_mov_b32 v79, 55
    ds_write_b32 v76, v79 offset:16384
    ds_read_b32 v78, v77 offset:256
    s_waitcnt vmcnt(5)
    s_cbranch_vccnz L_w111
    s_waitcnt vmcnt(4)
L_w111:
    buffer_load_dwordx4 v[132:135], v1, s[8:11], s28 offen nt
    s_xor_b32 s28, s26, 0x50d800
    v_mfma_f32_16x16x32_bf16 v[24:27], v[108:111], v[8:11], 0
    v_mov_b32_dpp v28, v20 quad_perm:[0,0,0,0] row_mask:0xf bank_mask:0xf
    v_mov_b32_dpp v29, v22 quad_perm:[2,2,2,2] row_mask:0xf bank_mask:0xf
    s_nop 0
    v_add_f32_dpp v28, v21, v28 quad_perm:[1,1,1,1] row_mask:0xf bank_mask:0xf
    v_add_f32_dpp v29, v23, v29 quad_perm:[3,3,3,3] row_mask:0xf bank_mask:0xf
    v_add_f32 v28, v28, v29
    v_cndmask_b32 v67, v67, v28, s[46:47]
    s_waitcnt vmcnt(5)
    s_cbranch_vccnz L_w112
    s_waitcnt vmcnt(4)
L_w112:
    buffer_load_dwordx4 v[136:139], v1, s[8:11], s28 offen nt
    s_xor_b32 s28, s26, 0x58dc00
    v_mfma_f32_16x16x32_bf16 v[12:15], v[112:115], v[8:11], 0
    v_mov_b32_dpp v28, v24 quad_perm:[0,0,0,0] row_mask:0xf bank_mask:0xf
    v_mov_b32_dpp v29, v26 quad_perm:[2,2,2,2] row_mask:0xf bank_mask:0xf
    s_nop 0
    v_add_f32_dpp v28, v25, v28 quad_perm:[1,1,1,1] row_mask:0xf bank_mask:0xf
    v_add_f32_dpp v29, v27, v29 quad_perm:[3,3,3,3] row_mask:0xf bank_mask:0xf
    v_add_f32 v28, v28, v29
    v_cndmask_b32 v67, v67, v28, s[48:49]
    v_cvt_pk_bf16_f32 v67, v67, v67
    v_and_b32 v67, 0xffff0000, v67
    v_mul_f32 v67, 0x3db504f3, v67
    v_cvt_pk_bf16_f32 v67, v67, v67
    v_and_b32 v67, 0xffff0000, v67
    v_max_f32 v6, v6, v67
    s_waitcnt lgkmcnt(0)
    v_cmp_lt_i32 vcc, 0, v78
    v_mov_b32 v79, 56
    ds_write_b32 v76, v79 offset:16384
    ds_read_b32 v78, v77 offset:256
    s_waitcnt vmcnt(5)
    s_cbranch_vccnz L_w113
    s_waitcnt vmcnt(4)
L_w113:
    buffer_load_dwordx4 v[140:143], v1, s[8:11], s28 offen nt
    s_xor_b32 s28, s26, 0x519000
    v_mfma_f32_16x16x32_bf16 v[16:19], v[116:119], v[8:11], 0
    v_mov_b32_dpp v28, v12 quad_perm:[0,0,0,0] row_mask:0xf bank_mask:0xf
    v_mov_b32_dpp v29, v14 quad_perm:[2,2,2,2] row_mask:0xf bank_mask:0xf
    s_nop 0
    v_add_f32_dpp v28, v13, v28 quad_perm:[1,1,1,1] row_mask:0xf bank_mask:0xf
    v_add_f32_dpp v29, v15, v29 quad_perm:[3,3,3,3] row_mask:0xf bank_mask:0xf
    v_add_f32 v68, v28, v29
    s_waitcnt vmcnt(5)
    s_cbranch_vccnz L_w114
    s_waitcnt vmcnt(4)
L_w114:
    buffer_load_dwordx4 v[144:147], v1, s[8:11], s28 offen nt
    s_xor_b32 s28, s26, 0x599400
    v_mfma_f32_16x16x32_bf16 v[20:23], v[120:123], v[8:11], 0
    v_mov_b32_dpp v28, v16 quad_perm:[0,0,0,0] row_mask:0xf bank_mask:0xf
    v_mov_b32_dpp v29, v18 quad_perm:[2,2,2,2] row_mask:0xf bank_mask:0xf
    s_nop 0
    v_add_f32_dpp v28, v17, v28 quad_perm:[1,1,1,1] row_mask:0xf bank_mask:0xf
    v_add_f32_dpp v29, v19, v29 quad_perm:[3,3,3,3] row_mask:0xf bank_mask:0xf
    v_add_f32 v28, v28, v29
    v_cndmask_b32 v68, v68, v28, s[44:45]
    s_waitcnt lgkmcnt(0)
    v_cmp_lt_i32 vcc, 2, v78
    v_mov_b32 v79, 57
    ds_write_b32 v76, v79 offset:16384
    ds_read_b32 v78, v77 offset:256
    s_waitcnt vmcnt(5)
    s_cbranch_vccnz L_w115
    s_waitcnt vmcnt(4)
L_w115:
    buffer_load_dwordx4 v[148:151], v1, s[8:11], s28 offen nt
    s_xor_b32 s28, s26, 0x519800
    v_mfma_f32_16x16x32_bf16 v[24:27], v[124:127], v[8:11], 0
    v_mov_b32_dpp v28, v20 quad_perm:[0,0,0,0] row_mask:0xf bank_mask:0xf
    v_mov_b32_dpp v29, v22 quad_perm:[2,2,2,2] row_mask:0xf bank_mask:0xf
    s_nop 0
    v_add_f32_dpp v28, v21, v28 quad_perm:[1,1,1,1] row_mask:0xf bank_mask:0xf
    v_add_f32_dpp v29, v23, v29 quad_perm:[3,3,3,3] row_mask:0xf bank_mask:0xf
    v_add_f32 v28, v28, v29
    v_cndmask_b32 v68, v68, v28, s[46:47]
    s_waitcnt vmcnt(5)
    s_cbranch_vccnz L_w116
    s_waitcnt vmcnt(4)
L_w116:
    buffer_load_dwordx4 v[152:155], v1, s[8:11], s28 offen nt
    s_xor_b32 s28, s26, 0x599c00
    v_mfma_f32_16x16x32_bf16 v[12:15], v[128:131], v[8:11], 0
    v_mov_b32_dpp v28, v24 quad_perm:[0,0,0,0] row_mask:0xf bank_mask:0xf
    v_mov_b32_dpp v29, v26 quad_perm:[2,2,2,2] row_mask:0xf bank_mask:0xf
    s_nop 0
    v_add_f32_dpp v28, v25, v28 quad_perm:[1,1,1,1] row_mask:0xf bank_mask:0xf
    v_add_f32_dpp v29, v27, v29 quad_perm:[3,3,3,3] row_mask:0xf bank_mask:0xf
    v_add_f32 v28, v28, v29
    v_cndmask_b32 v68, v68, v28, s[48:49]
    v_cvt_pk_bf16_f32 v68, v68, v68
    v_and_b32 v68, 0xffff0000, v68
    v_mul_f32 v68, 0x3db504f3, v68
    v_cvt_pk_bf16_f32 v68, v68, v68
    v_and_b32 v68, 0xffff0000, v68
    v_max_f32 v6, v6, v68
    s_waitcnt lgkmcnt(0)
    v_cmp_lt_i32 vcc, 1, v78
    v_mov_b32 v79, 58
    ds_write_b32 v76, v79 offset:16384
    ds_read_b32 v78, v77 offset:256
    s_waitcnt vmcnt(5)
    s_cbranch_vccnz L_w117
    s_waitcnt vmcnt(4)
L_w117:
    buffer_load_dwordx4 v[156:159], v1, s[8:11], s28 offen nt
    s_xor_b32 s28, s26, 0x51d000
    v_mfma_f32_16x16x32_bf16 v[16:19], v[132:135], v[8:11], 0
    v_mov_b32_dpp v28, v12 quad_perm:[0,0,0,0] row_mask:0xf bank_mask:0xf
    v_mov_b32_dpp v29, v14 quad_perm:[2,2,2,2] row_mask:0xf bank_mask:0xf
    s_nop 0
    v_add_f32_dpp v28, v13, v28 quad_perm:[1,1,1,1] row_mask:0xf bank_mask:0xf
    v_add_f32_dpp v29, v15, v29 quad_perm:[3,3,3,3] row_mask:0xf bank_mask:0xf
    v_add_f32 v69, v28, v29
    s_waitcnt vmcnt(5)
    s_cbranch_vccnz L_w118
    s_waitcnt vmcnt(4)
L_w118:
    buffer_load_dwordx4 v[160:163], v1, s[8:11], s28 offen nt
    s_xor_b32 s28, s26, 0x59d400
    v_mfma_f32_16x16x32_bf16 v[20:23], v[136:139], v[8:11], 0
    v_mov_b32_dpp v28, v16 quad_perm:[0,0,0,0] row_mask:0xf bank_mask:0xf
    v_mov_b32_dpp v29, v18 quad_perm:[2,2,2,2] row_mask:0xf bank_mask:0xf
    s_nop 0
    v_add_f32_dpp v28, v17, v28 quad_perm:[1,1,1,1] row_mask:0xf bank_mask:0xf
    v_add_f32_dpp v29, v19, v29 quad_perm:[3,3,3,3] row_mask:0xf bank_mask:0xf
    v_add_f32 v28, v28, v29
    v_cndmask_b32 v69, v69, v28, s[44:45]
L_pad17:
    s_cmp_eq_u32 s51, 1
    s_cbranch_scc1 L_pad18
    s_waitcnt lgkmcnt(0)
    v_cmp_lt_i32 vcc, 3, v78
    v_mov_b32 v79, 59
    ds_write_b32 v76, v79 offset:16384
    ds_read_b32 v78, v77 offset:256
    s_waitcnt vmcnt(5)
    s_cbranch_vccnz L_w119
    s_waitcnt vmcnt(4)
L_w119:
    buffer_load_dwordx4 v[164:167], v1, s[8:11], s28 offen nt
    s_xor_b32 s28, s26, 0x51d800
    v_mfma_f32_16x16x32_bf16 v[24:27], v[140:143], v[8:11], 0
    v_mov_b32_dpp v28, v20 quad_perm:[0,0,0,0] row_mask:0xf bank_mask:0xf
    v_mov_b32_dpp v29, v22 quad_perm:[2,2,2,2] row_mask:0xf bank_mask:0xf
    s_nop 0
    v_add_f32_dpp v28, v21, v28 quad_perm:[1,1,1,1] row_mask:0xf bank_mask:0xf
    v_add_f32_dpp v29, v23, v29 quad_perm:[3,3,3,3] row_mask:0xf bank_mask:0xf
    v_add_f32 v28, v28, v29
    v_cndmask_b32 v69, v69, v28, s[46:47]
    s_waitcnt vmcnt(5)
    s_cbranch_vccnz L_w120
    s_waitcnt vmcnt(4)
L_w120:
    buffer_load_dwordx4 v[168:171], v1, s[8:11], s28 offen nt
    s_xor_b32 s28, s26, 0x59dc00
    v_mfma_f32_16x16x32_bf16 v[12:15], v[144:147], v[8:11], 0
    v_mov_b32_dpp v28, v24 quad_perm:[0,0,0,0] row_mask:0xf bank_mask:0xf
    v_mov_b32_dpp v29, v26 quad_perm:[2,2,2,2] row_mask:0xf bank_mask:0xf
    s_nop 0
    v_add_f32_dpp v28, v25, v28 quad_perm:[1,1,1,1] row_mask:0xf bank_mask:0xf
    v_add_f32_dpp v29, v27, v29 quad_perm:[3,3,3,3] row_mask:0xf bank_mask:0xf
    v_add_f32 v28, v28, v29
    v_cndmask_b32 v69, v69, v28, s[48:49]
    v_cvt_pk_bf16_f32 v69, v69, v69
    v_and_b32 v69, 0xffff0000, v69
    v_mul_f32 v69, 0x3db504f3, v69
    v_cvt_pk_bf16_f32 v69, v69, v69
    v_and_b32 v69, 0xffff0000, v69
    v_max_f32 v6, v6, v69
    s_waitcnt lgkmcnt(0)
    v_cmp_lt_i32 vcc, 0, v78
    v_mov_b32 v79, 60
    ds_write_b32 v76, v79 offset:16384
    ds_read_b32 v78, v77 offset:256
    s_waitcnt vmcnt(5)
    s_cbranch_vccnz L_w121
    s_waitcnt vmcnt(4)
L_w121:
    buffer_load_dwordx4 v[172:175], v1, s[8:11], s28 offen nt
    s_xor_b32 s28, s26, 0x529400
    v_mfma_f32_16x16x32_bf16 v[16:19], v[148:151], v[8:11], 0
    v_mov_b32_dpp v28, v12 quad_perm:[0,0,0,0] row_mask:0xf bank_mask:0xf
    v_mov_b32_dpp v29, v14 quad_perm:[2,2,2,2] row_mask:0xf bank_mask:0xf
    s_nop 0
    v_add_f32_dpp v28, v13, v28 quad_perm:[1,1,1,1] row_mask:0xf bank_mask:0xf
    v_add_f32_dpp v29, v15, v29 quad_perm:[3,3,3,3] row_mask:0xf bank_mask:0xf
    v_add_f32 v70, v28, v29
    s_waitcnt vmcnt(5)
    s_cbranch_vccnz L_w122
    s_waitcnt vmcnt(4)
L_w122:
    buffer_load_dwordx4 v[176:179], v1, s[8:11], s28 offen nt
    s_xor_b32 s28, s26, 0x5a9000
    v_mfma_f32_16x16x32_bf16 v[20:23], v[152:155], v[8:11], 0
    v_mov_b32_dpp v28, v16 quad_perm:[0,0,0,0] row_mask:0xf bank_mask:0xf
    v_mov_b32_dpp v29, v18 quad_perm:[2,2,2,2] row_mask:0xf bank_mask:0xf
    s_nop 0
    v_add_f32_dpp v28, v17, v28 quad_perm:[1,1,1,1] row_mask:0xf bank_mask:0xf
    v_add_f32_dpp v29, v19, v29 quad_perm:[3,3,3,3] row_mask:0xf bank_mask:0xf
    v_add_f32 v28, v28, v29
    v_cndmask_b32 v70, v70, v28, s[44:45]
    s_waitcnt lgkmcnt(0)
    v_cmp_lt_i32 vcc, 2, v78
    v_mov_b32 v79, 61
    ds_write_b32 v76, v79 offset:16384
    ds_read_b32 v78, v77 offset:256
    s_waitcnt vmcnt(5)
    s_cbranch_vccnz L_w123
    s_waitcnt vmcnt(4)
L_w123:
    buffer_load_dwordx4 v[180:183], v1, s[8:11], s28 offen nt
    s_xor_b32 s28, s26, 0x529c00
    v_mfma_f32_16x16x32_bf16 v[24:27], v[156:159], v[8:11], 0
    v_mov_b32_dpp v28, v20 quad_perm:[0,0,0,0] row_mask:0xf bank_mask:0xf
    v_mov_b32_dpp v29, v22 quad_perm:[2,2,2,2] row_mask:0xf bank_mask:0xf
    s_nop 0
    v_add_f32_dpp v28, v21, v28 quad_perm:[1,1,1,1] row_mask:0xf bank_mask:0xf
    v_add_f32_dpp v29, v23, v29 quad_perm:[3,3,3,3] row_mask:0xf bank_mask:0xf
    v_add_f32 v28, v28, v29
    v_cndmask_b32 v70, v70, v28, s[46:47]
    s_waitcnt vmcnt(5)
    s_cbranch_vccnz L_w124
    s_waitcnt vmcnt(4)
L_w124:
    buffer_load_dwordx4 v[184:187], v1, s[8:11], s28 offen nt
    s_xor_b32 s28, s26, 0x5a9800
    v_mfma_f32_16x16x32_bf16 v[12:15], v[160:163], v[8:11], 0
    v_mov_b32_dpp v28, v24 quad_perm:[0,0,0,0] row_mask:0xf bank_mask:0xf
    v_mov_b32_dpp v29, v26 quad_perm:[2,2,2,2] row_mask:0xf bank_mask:0xf
    s_nop 0
    v_add_f32_dpp v28, v25, v28 quad_perm:[1,1,1,1] row_mask:0xf bank_mask:0xf
    v_add_f32_dpp v29, v27, v29 quad_perm:[3,3,3,3] row_mask:0xf bank_mask:0xf
    v_add_f32 v28, v28, v29
    v_cndmask_b32 v70, v70, v28, s[48:49]
    v_cvt_pk_bf16_f32 v70, v70, v70
    v_and_b32 v70, 0xffff0000, v70
    v_mul_f32 v70, 0x3db504f3, v70
    v_cvt_pk_bf16_f32 v70, v70, v70
    v_and_b32 v70, 0xffff0000, v70
    v_max_f32 v6, v6, v70
    s_waitcnt lgkmcnt(0)
    v_cmp_lt_i32 vcc, 1, v78
    v_mov_b32 v79, 62
    ds_write_b32 v76, v79 offset:16384
    ds_read_b32 v78, v77 offset:256
    s_waitcnt vmcnt(5)
    s_cbranch_vccnz L_w125
    s_waitcnt vmcnt(4)
L_w125:
    buffer_load_dwordx4 v[188:191], v1, s[8:11], s28 offen nt
    s_xor_b32 s28, s26, 0x52d400
    v_mfma_f32_16x16x32_bf16 v[16:19], v[164:167], v[8:11], 0
    v_mov_b32_dpp v28, v12 quad_perm:[0,0,0,0] row_mask:0xf bank_mask:0xf
    v_mov_b32_dpp v29, v14 quad_perm:[2,2,2,2] row_mask:0xf bank_mask:0xf
    s_nop 0
    v_add_f32_dpp v28, v13, v28 quad_perm:[1,1,1,1] row_mask:0xf bank_mask:0xf
    v_add_f32_dpp v29, v15, v29 quad_perm:[3,3,3,3] row_mask:0xf bank_mask:0xf
    v_add_f32 v71, v28, v29
    s_waitcnt vmcnt(5)
    s_cbranch_vccnz L_w126
    s_waitcnt vmcnt(4)
L_w126:
    buffer_load_dwordx4 v[192:195], v1, s[8:11], s28 offen nt
    s_xor_b32 s28, s26, 0x5ad000
    v_mfma_f32_16x16x32_bf16 v[20:23], v[168:171], v[8:11], 0
    v_mov_b32_dpp v28, v16 quad_perm:[0,0,0,0] row_mask:0xf bank_mask:0xf
    v_mov_b32_dpp v29, v18 quad_perm:[2,2,2,2] row_mask:0xf bank_mask:0xf
    s_nop 0
    v_add_f32_dpp v28, v17, v28 quad_perm:[1,1,1,1] row_mask:0xf bank_mask:0xf
    v_add_f32_dpp v29, v19, v29 quad_perm:[3,3,3,3] row_mask:0xf bank_mask:0xf
    v_add_f32 v28, v28, v29
    v_cndmask_b32 v71, v71, v28, s[44:45]
    s_waitcnt lgkmcnt(0)
    v_cmp_lt_i32 vcc, 3, v78
    v_mov_b32 v79, 63
    ds_write_b32 v76, v79 offset:16384
    ds_read_b32 v78, v77 offset:256
    s_waitcnt vmcnt(5)
    s_cbranch_vccnz L_w127
    s_waitcnt vmcnt(4)
L_w127:
    buffer_load_dwordx4 v[196:199], v1, s[8:11], s28 offen nt
    s_xor_b32 s28, s26, 0x52dc00
    v_mfma_f32_16x16x32_bf16 v[24:27], v[172:175], v[8:11], 0
    v_mov_b32_dpp v28, v20 quad_perm:[0,0,0,0] row_mask:0xf bank_mask:0xf
    v_mov_b32_dpp v29, v22 quad_perm:[2,2,2,2] row_mask:0xf bank_mask:0xf
    s_nop 0
    v_add_f32_dpp v28, v21, v28 quad_perm:[1,1,1,1] row_mask:0xf bank_mask:0xf
    v_add_f32_dpp v29, v23, v29 quad_perm:[3,3,3,3] row_mask:0xf bank_mask:0xf
    v_add_f32 v28, v28, v29
    v_cndmask_b32 v71, v71, v28, s[46:47]
    s_waitcnt vmcnt(5)
    s_cbranch_vccnz L_w128
    s_waitcnt vmcnt(4)
L_w128:
    buffer_load_dwordx4 v[200:203], v1, s[8:11], s28 offen nt
    s_xor_b32 s28, s26, 0x5ad800
    v_mfma_f32_16x16x32_bf16 v[12:15], v[176:179], v[8:11], 0
    v_mov_b32_dpp v28, v24 quad_perm:[0,0,0,0] row_mask:0xf bank_mask:0xf
    v_mov_b32_dpp v29, v26 quad_perm:[2,2,2,2] row_mask:0xf bank_mask:0xf
L_pad18:
    s_cmp_eq_u32 s51, 1
    s_cbranch_scc1 L_pad19
    s_nop 0
    v_add_f32_dpp v28, v25, v28 quad_perm:[1,1,1,1] row_mask:0xf bank_mask:0xf
    v_add_f32_dpp v29, v27, v29 quad_perm:[3,3,3,3] row_mask:0xf bank_mask:0xf
    v_add_f32 v28, v28, v29
    v_cndmask_b32 v71, v71, v28, s[48:49]
    v_cvt_pk_bf16_f32 v71, v71, v71
    v_and_b32 v71, 0xffff0000, v71
    v_mul_f32 v71, 0x3db504f3, v71
    v_cvt_pk_bf16_f32 v71, v71, v71
    v_and_b32 v71, 0xffff0000, v71
    v_max_f32 v6, v6, v71
    s_waitcnt lgkmcnt(0)
    v_cmp_lt_i32 vcc, 0, v78
    v_mov_b32 v79, 64
    ds_write_b32 v76, v79 offset:16384
    ds_read_b32 v78, v77 offset:256
    s_waitcnt vmcnt(5)
    s_cbranch_vccnz L_w129
    s_waitcnt vmcnt(4)
L_w129:
    buffer_load_dwordx4 v[204:207], v1, s[8:11], s28 offen nt
    s_xor_b32 s28, s26, 0x539400
    v_mfma_f32_16x16x32_bf16 v[16:19], v[180:183], v[8:11], 0
    v_mov_b32_dpp v28, v12 quad_perm:[0,0,0,0] row_mask:0xf bank_mask:0xf
    v_mov_b32_dpp v29, v14 quad_perm:[2,2,2,2] row_mask:0xf bank_mask:0xf
    s_nop 0
    v_add_f32_dpp v28, v13, v28 quad_perm:[1,1,1,1] row_mask:0xf bank_mask:0xf
    v_add_f32_dpp v29, v15, v29 quad_perm:[3,3,3,3] row_mask:0xf bank_mask:0xf
    v_add_f32 v72, v28, v29
    s_waitcnt vmcnt(5)
    s_cbranch_vccnz L_w130
    s_waitcnt vmcnt(4)
L_w130:
    buffer_load_dwordx4 v[208:211], v1, s[8:11], s28 offen nt
    s_xor_b32 s28, s26, 0x5b9000
    v_mfma_f32_16x16x32_bf16 v[20:23], v[184:187], v[8:11], 0
    v_mov_b32_dpp v28, v16 quad_perm:[0,0,0,0] row_mask:0xf bank_mask:0xf
    v_mov_b32_dpp v29, v18 quad_perm:[2,2,2,2] row_mask:0xf bank_mask:0xf
    s_nop 0
    v_add_f32_dpp v28, v17, v28 quad_perm:[1,1,1,1] row_mask:0xf bank_mask:0xf
    v_add_f32_dpp v29, v19, v29 quad_perm:[3,3,3,3] row_mask:0xf bank_mask:0xf
    v_add_f32 v28, v28, v29
    v_cndmask_b32 v72, v72, v28, s[44:45]
    s_waitcnt lgkmcnt(0)
    v_cmp_lt_i32 vcc, 2, v78
    v_mov_b32 v79, 65
    ds_write_b32 v76, v79 offset:16384
    ds_read_b32 v78, v77 offset:256
    s_waitcnt vmcnt(5)
    s_cbranch_vccnz L_w131
    s_waitcnt vmcnt(4)
L_w131:
    buffer_load_dwordx4 v[212:215], v1, s[8:11], s28 offen nt
    s_xor_b32 s28, s26, 0x539c00
    v_mfma_f32_16x16x32_bf16 v[24:27], v[188:191], v[8:11], 0
    v_mov_b32_dpp v28, v20 quad_perm:[0,0,0,0] row_mask:0xf bank_mask:0xf
    v_mov_b32_dpp v29, v22 quad_perm:[2,2,2,2] row_mask:0xf bank_mask:0xf
    s_nop 0
    v_add_f32_dpp v28, v21, v28 quad_perm:[1,1,1,1] row_mask:0xf bank_mask:0xf
    v_add_f32_dpp v29, v23, v29 quad_perm:[3,3,3,3] row_mask:0xf bank_mask:0xf
    v_add_f32 v28, v28, v29
    v_cndmask_b32 v72, v72, v28, s[46:47]
    s_waitcnt vmcnt(5)
    s_cbranch_vccnz L_w132
    s_waitcnt vmcnt(4)
L_w132:
    buffer_load_dwordx4 v[216:219], v1, s[8:11], s28 offen nt
    s_xor_b32 s28, s26, 0x5b9800
    v_mfma_f32_16x16x32_bf16 v[12:15], v[192:195], v[8:11], 0
    v_mov_b32_dpp v28, v24 quad_perm:[0,0,0,0] row_mask:0xf bank_mask:0xf
    v_mov_b32_dpp v29, v26 quad_perm:[2,2,2,2] row_mask:0xf bank_mask:0xf
    s_nop 0
    v_add_f32_dpp v28, v25, v28 quad_perm:[1,1,1,1] row_mask:0xf bank_mask:0xf
    v_add_f32_dpp v29, v27, v29 quad_perm:[3,3,3,3] row_mask:0xf bank_mask:0xf
    v_add_f32 v28, v28, v29
    v_cndmask_b32 v72, v72, v28, s[48:49]
    v_cvt_pk_bf16_f32 v72, v72, v72
    v_and_b32 v72, 0xffff0000, v72
    v_mul_f32 v72, 0x3db504f3, v72
    v_cvt_pk_bf16_f32 v72, v72, v72
    v_and_b32 v72, 0xffff0000, v72
    v_max_f32 v6, v6, v72
    s_waitcnt lgkmcnt(0)
    v_cmp_lt_i32 vcc, 1, v78
    v_mov_b32 v79, 66
    ds_write_b32 v76, v79 offset:16384
    ds_read_b32 v78, v77 offset:256
    s_waitcnt vmcnt(5)
    s_cbranch_vccnz L_w133
    s_waitcnt vmcnt(4)
L_w133:
    buffer_load_dwordx4 v[220:223], v1, s[8:11], s28 offen nt
    s_xor_b32 s28, s26, 0x53d400
    v_mfma_f32_16x16x32_bf16 v[16:19], v[196:199], v[8:11], 0
    v_mov_b32_dpp v28, v12 quad_perm:[0,0,0,0] row_mask:0xf bank_mask:0xf
    v_mov_b32_dpp v29, v14 quad_perm:[2,2,2,2] row_mask:0xf bank_mask:0xf
    s_nop 0
    v_add_f32_dpp v28, v13, v28 quad_perm:[1,1,1,1] row_mask:0xf bank_mask:0xf
    v_add_f32_dpp v29, v15, v29 quad_perm:[3,3,3,3] row_mask:0xf bank_mask:0xf
    v_add_f32 v73, v28, v29
    s_waitcnt vmcnt(5)
    s_cbranch_vccnz L_w134
    s_waitcnt vmcnt(4)
L_w134:
    buffer_load_dwordx4 v[224:227], v1, s[8:11], s28 offen nt
    s_xor_b32 s28, s26, 0x5bd000
    v_mfma_f32_16x16x32_bf16 v[20:23], v[200:203], v[8:11], 0
    v_mov_b32_dpp v28, v16 quad_perm:[0,0,0,0] row_mask:0xf bank_mask:0xf
    v_mov_b32_dpp v29, v18 quad_perm:[2,2,2,2] row_mask:0xf bank_mask:0xf
    s_nop 0
    v_add_f32_dpp v28, v17, v28 quad_perm:[1,1,1,1] row_mask:0xf bank_mask:0xf
    v_add_f32_dpp v29, v19, v29 quad_perm:[3,3,3,3] row_mask:0xf bank_mask:0xf
    v_add_f32 v28, v28, v29
    v_cndmask_b32 v73, v73, v28, s[44:45]
    s_waitcnt lgkmcnt(0)
    v_cmp_lt_i32 vcc, 3, v78
    v_mov_b32 v79, 67
    ds_write_b32 v76, v79 offset:16384
    ds_read_b32 v78, v77 offset:256
    s_waitcnt vmcnt(5)
    s_cbranch_vccnz L_w135
    s_waitcnt vmcnt(4)
L_w135:
    buffer_load_dwordx4 v[228:231], v1, s[8:11], s28 offen nt
    s_xor_b32 s28, s26, 0x53dc00
    v_mfma_f32_16x16x32_bf16 v[24:27], v[204:207], v[8:11], 0
    v_mov_b32_dpp v28, v20 quad_perm:[0,0,0,0] row_mask:0xf bank_mask:0xf
    v_mov_b32_dpp v29, v22 quad_perm:[2,2,2,2] row_mask:0xf bank_mask:0xf
    s_nop 0
    v_add_f32_dpp v28, v21, v28 quad_perm:[1,1,1,1] row_mask:0xf bank_mask:0xf
    v_add_f32_dpp v29, v23, v29 quad_perm:[3,3,3,3] row_mask:0xf bank_mask:0xf
    v_add_f32 v28, v28, v29
    v_cndmask_b32 v73, v73, v28, s[46:47]
    s_waitcnt vmcnt(5)
    s_cbranch_vccnz L_w136
    s_waitcnt vmcnt(4)
L_w136:
    buffer_load_dwordx4 v[232:235], v1, s[8:11], s28 offen nt
    s_xor_b32 s28, s26, 0x5bd800
    v_mfma_f32_16x16x32_bf16 v[12:15], v[208:211], v[8:11], 0
    v_mov_b32_dpp v28, v24 quad_perm:[0,0,0,0] row_mask:0xf bank_mask:0xf
    v_mov_b32_dpp v29, v26 quad_perm:[2,2,2,2] row_mask:0xf bank_mask:0xf
    s_nop 0
    v_add_f32_dpp v28, v25, v28 quad_perm:[1,1,1,1] row_mask:0xf bank_mask:0xf
    v_add_f32_dpp v29, v27, v29 quad_perm:[3,3,3,3] row_mask:0xf bank_mask:0xf
    v_add_f32 v28, v28, v29
    v_cndmask_b32 v73, v73, v28, s[48:49]
    v_cvt_pk_bf16_f32 v73, v73, v73
    v_and_b32 v73, 0xffff0000, v73
    v_mul_f32 v73, 0x3db504f3, v73
    v_cvt_pk_bf16_f32 v73, v73, v73
    v_and_b32 v73, 0xffff0000, v73
    v_max_f32 v6, v6, v73
    s_waitcnt lgkmcnt(0)
    v_cmp_lt_i32 vcc, 0, v78
    v_mov_b32 v79, 68
    ds_write_b32 v76, v79 offset:16384
    ds_read_b32 v78, v77 offset:256
    s_waitcnt vmcnt(5)
    s_cbranch_vccnz L_w137
    s_waitcnt vmcnt(4)
L_w137:
    buffer_load_dwordx4 v[80:83], v1, s[8:11], s28 offen nt
    s_xor_b32 s28, s26, 0x0
    v_mfma_f32_16x16x32_bf16 v[16:19], v[212:215], v[8:11], 0
    v_mov_b32_dpp v28, v12 quad_perm:[0,0,0,0] row_mask:0xf bank_mask:0xf
    v_mov_b32_dpp v29, v14 quad_perm:[2,2,2,2] row_mask:0xf bank_mask:0xf
L_pad19:
    s_cmp_eq_u32 s51, 1
    s_cbranch_scc1 L_pad20
    s_nop 0
    v_add_f32_dpp v28, v13, v28 quad_perm:[1,1,1,1] row_mask:0xf bank_mask:0xf
    v_add_f32_dpp v29, v15, v29 quad_perm:[3,3,3,3] row_mask:0xf bank_mask:0xf
    v_add_f32 v74, v28, v29
    s_waitcnt vmcnt(5)
    s_cbranch_vccnz L_w138
    s_waitcnt vmcnt(4)
L_w138:
    buffer_load_dwordx4 v[84:87], v2, s[12:15], s28 offen nt
    s_xor_b32 s28, s26, 0x80400
    v_mfma_f32_16x16x32_bf16 v[20:23], v[216:219], v[8:11], 0
    v_mov_b32_dpp v28, v16 quad_perm:[0,0,0,0] row_mask:0xf bank_mask:0xf
    v_mov_b32_dpp v29, v18 quad_perm:[2,2,2,2] row_mask:0xf bank_mask:0xf
    s_nop 0
    v_add_f32_dpp v28, v17, v28 quad_perm:[1,1,1,1] row_mask:0xf bank_mask:0xf
    v_add_f32_dpp v29, v19, v29 quad_perm:[3,3,3,3] row_mask:0xf bank_mask:0xf
    v_add_f32 v28, v28, v29
    v_cndmask_b32 v74, v74, v28, s[44:45]
    s_waitcnt lgkmcnt(0)
    v_cmp_lt_i32 vcc, 2, v78
    v_mov_b32 v79, 69
    ds_write_b32 v76, v79 offset:16384
    ds_read_b32 v78, v77 offset:256
    s_waitcnt vmcnt(5)
    s_cbranch_vccnz L_w139
    s_waitcnt vmcnt(4)
L_w139:
    buffer_load_dwordx4 v[88:91], v2, s[12:15], s28 offen nt
    s_xor_b32 s28, s26, 0x800
    v_mfma_f32_16x16x32_bf16 v[24:27], v[220:223], v[8:11], 0
    v_mov_b32_dpp v28, v20 quad_perm:[0,0,0,0] row_mask:0xf bank_mask:0xf
    v_mov_b32_dpp v29, v22 quad_perm:[2,2,2,2] row_mask:0xf bank_mask:0xf
    s_nop 0
    v_add_f32_dpp v28, v21, v28 quad_perm:[1,1,1,1] row_mask:0xf bank_mask:0xf
    v_add_f32_dpp v29, v23, v29 quad_perm:[3,3,3,3] row_mask:0xf bank_mask:0xf
    v_add_f32 v28, v28, v29
    v_cndmask_b32 v74, v74, v28, s[46:47]
    s_waitcnt vmcnt(5)
    s_cbranch_vccnz L_w140
    s_waitcnt vmcnt(4)
L_w140:
    buffer_load_dwordx4 v[92:95], v2, s[12:15], s28 offen nt
    s_xor_b32 s28, s26, 0x80c00
    v_mfma_f32_16x16x32_bf16 v[12:15], v[224:227], v[8:11], 0
    v_mov_b32_dpp v28, v24 quad_perm:[0,0,0,0] row_mask:0xf bank_mask:0xf
    v_mov_b32_dpp v29, v26 quad_perm:[2,2,2,2] row_mask:0xf bank_mask:0xf
    s_nop 0
    v_add_f32_dpp v28, v25, v28 quad_perm:[1,1,1,1] row_mask:0xf bank_mask:0xf
    v_add_f32_dpp v29, v27, v29 quad_perm:[3,3,3,3] row_mask:0xf bank_mask:0xf
    v_add_f32 v28, v28, v29
    v_cndmask_b32 v74, v74, v28, s[48:49]
    v_cvt_pk_bf16_f32 v74, v74, v74
    v_and_b32 v74, 0xffff0000, v74
    v_mul_f32 v74, 0x3db504f3, v74
    v_cvt_pk_bf16_f32 v74, v74, v74
    v_and_b32 v74, 0xffff0000, v74
    v_max_f32 v6, v6, v74
    s_waitcnt lgkmcnt(0)
    v_cmp_lt_i32 vcc, 1, v78
    v_mov_b32 v79, 70
    ds_write_b32 v76, v79 offset:16384
    ds_read_b32 v78, v77 offset:256
    s_waitcnt vmcnt(5)
    s_cbranch_vccnz L_w141
    s_waitcnt vmcnt(4)
L_w141:
    buffer_load_dwordx4 v[96:99], v2, s[12:15], s28 offen nt
    s_xor_b32 s28, s26, 0x4000
    v_mfma_f32_16x16x32_bf16 v[16:19], v[228:231], v[8:11], 0
    v_mov_b32_dpp v28, v12 quad_perm:[0,0,0,0] row_mask:0xf bank_mask:0xf
    v_mov_b32_dpp v29, v14 quad_perm:[2,2,2,2] row_mask:0xf bank_mask:0xf
    s_nop 0
    v_add_f32_dpp v28, v13, v28 quad_perm:[1,1,1,1] row_mask:0xf bank_mask:0xf
    v_add_f32_dpp v29, v15, v29 quad_perm:[3,3,3,3] row_mask:0xf bank_mask:0xf
    v_add_f32 v75, v28, v29
    s_waitcnt vmcnt(5)
    s_cbranch_vccnz L_w142
    s_waitcnt vmcnt(4)
L_w142:
    buffer_load_dwordx4 v[100:103], v2, s[12:15], s28 offen nt
    s_xor_b32 s28, s26, 0x84400
    v_mfma_f32_16x16x32_bf16 v[20:23], v[232:235], v[8:11], 0
    v_mov_b32_dpp v28, v16 quad_perm:[0,0,0,0] row_mask:0xf bank_mask:0xf
    v_mov_b32_dpp v29, v18 quad_perm:[2,2,2,2] row_mask:0xf bank_mask:0xf
    s_nop 0
    v_add_f32_dpp v28, v17, v28 quad_perm:[1,1,1,1] row_mask:0xf bank_mask:0xf
    v_add_f32_dpp v29, v19, v29 quad_perm:[3,3,3,3] row_mask:0xf bank_mask:0xf
    v_add_f32 v28, v28, v29
    v_cndmask_b32 v75, v75, v28, s[44:45]
    s_waitcnt lgkmcnt(0)
    v_cmp_lt_i32 vcc, 3, v78
    v_mov_b32 v79, 71
    ds_write_b32 v76, v79 offset:16384
    ds_read_b32 v78, v77 offset:256
    s_waitcnt vmcnt(5)
    s_cbranch_vccnz L_w143
    s_waitcnt vmcnt(4)
L_w143:
    buffer_load_dwordx4 v[104:107], v2, s[12:15], s28 offen nt
    s_xor_b32 s28, s26, 0x4800
    v_mfma_f32_16x16x32_bf16 v[24:27], v[80:83], v[8:11], 0
    v_mov_b32_dpp v28, v20 quad_perm:[0,0,0,0] row_mask:0xf bank_mask:0xf
    v_mov_b32_dpp v29, v22 quad_perm:[2,2,2,2] row_mask:0xf bank_mask:0xf
    s_nop 0
    v_add_f32_dpp v28, v21, v28 quad_perm:[1,1,1,1] row_mask:0xf bank_mask:0xf
    v_add_f32_dpp v29, v23, v29 quad_perm:[3,3,3,3] row_mask:0xf bank_mask:0xf
    v_add_f32 v28, v28, v29
    v_cndmask_b32 v75, v75, v28, s[46:47]
    s_waitcnt vmcnt(5)
    s_cbranch_vccnz L_w144
    s_waitcnt vmcnt(4)
L_w144:
    buffer_load_dwordx4 v[108:111], v2, s[12:15], s28 offen nt
    s_xor_b32 s28, s26, 0x84c00
    v_mov_b32_dpp v28, v24 quad_perm:[0,0,0,0] row_mask:0xf bank_mask:0xf
    v_mov_b32_dpp v29, v26 quad_perm:[2,2,2,2] row_mask:0xf bank_mask:0xf
    s_nop 0
    v_add_f32_dpp v28, v25, v28 quad_perm:[1,1,1,1] row_mask:0xf bank_mask:0xf
    v_add_f32_dpp v29, v27, v29 quad_perm:[3,3,3,3] row_mask:0xf bank_mask:0xf
    v_add_f32 v28, v28, v29
    v_cndmask_b32 v75, v75, v28, s[48:49]
    v_cvt_pk_bf16_f32 v75, v75, v75
    v_and_b32 v75, 0xffff0000, v75
    v_mul_f32 v75, 0x3db504f3, v75
    v_cvt_pk_bf16_f32 v75, v75, v75
    v_and_b32 v75, 0xffff0000, v75
    v_max_f32 v6, v6, v75
    s_nop 1
    v_max_f32_dpp v6, v6, v6 quad_perm:[1,0,3,2] row_mask:0xf bank_mask:0xf
    s_nop 1
    v_max_f32_dpp v6, v6, v6 quad_perm:[2,3,0,1] row_mask:0xf bank_mask:0xf
    v_mov_b32 v3, v6
    s_nop 1
    v_permlane16_swap_b32 v3, v6
    v_max_f32 v6, v6, v3
    v_mov_b32 v3, v6
    s_nop 1
    v_permlane32_swap_b32 v3, v6
    v_max_f32 v6, v6, v3
    v_mov_b32 v7, 0
    s_waitcnt lgkmcnt(0)
    v_cmp_lt_i32 vcc, 0, v78
    v_mov_b32 v79, 72
    ds_write_b32 v76, v79 offset:16384
    ds_read_b32 v78, v77 offset:256
    s_waitcnt vmcnt(5)
    s_cbranch_vccnz L_w145
    s_waitcnt vmcnt(4)
L_w145:
    buffer_load_dwordx4 v[112:115], v2, s[12:15], s28 offen nt
    s_xor_b32 s28, s26, 0x10000
    v_sub_f32 v44, v44, v6
    v_sub_f32 v45, v45, v6
    v_sub_f32 v46, v46, v6
    v_sub_f32 v47, v47, v6
    v_sub_f32 v48, v48, v6
    v_sub_f32 v49, v49, v6
    v_sub_f32 v50, v50, v6
    v_sub_f32 v51, v51, v6
    v_mul_f32 v44, 0x3fb8aa3b, v44
    v_mul_f32 v45, 0x3fb8aa3b, v45
    v_mul_f32 v46, 0x3fb8aa3b, v46
    v_mul_f32 v47, 0x3fb8aa3b, v47
    v_mul_f32 v48, 0x3fb8aa3b, v48
    v_mul_f32 v49, 0x3fb8aa3b, v49
    v_mul_f32 v50, 0x3fb8aa3b, v50
    v_mul_f32 v51, 0x3fb8aa3b, v51
    v_exp_f32 v44, v44
    v_exp_f32 v45, v45
    v_exp_f32 v46, v46
    v_exp_f32 v47, v47
    v_exp_f32 v48, v48
    v_exp_f32 v49, v49
    v_exp_f32 v50, v50
    v_exp_f32 v51, v51
L_pad20:
    s_cmp_eq_u32 s51, 1
    s_cbranch_scc1 L_pad21
    v_add_f32 v7, v7, v44
    v_add_f32 v7, v7, v45
    v_add_f32 v7, v7, v46
    v_add_f32 v7, v7, v47
    v_add_f32 v7, v7, v48
    v_add_f32 v7, v7, v49
    v_add_f32 v7, v7, v50
    v_add_f32 v7, v7, v51
    v_cvt_pk_bf16_f32 v44, v44, v44
    v_cvt_pk_bf16_f32 v45, v45, v45
    v_cvt_pk_bf16_f32 v46, v46, v46
    v_cvt_pk_bf16_f32 v47, v47, v47
    v_cvt_pk_bf16_f32 v48, v48, v48
    v_cvt_pk_bf16_f32 v49, v49, v49
    v_cvt_pk_bf16_f32 v50, v50, v50
    v_cvt_pk_bf16_f32 v51, v51, v51
    s_waitcnt vmcnt(5)
    s_cbranch_vccnz L_w146
    s_waitcnt vmcnt(4)
L_w146:
    buffer_load_dwordx4 v[116:119], v2, s[12:15], s28 offen nt
    s_xor_b32 s28, s26, 0x90400
    v_sub_f32 v52, v52, v6
    v_sub_f32 v53, v53, v6
    v_sub_f32 v54, v54, v6
    v_sub_f32 v55, v55, v6
    v_sub_f32 v56, v56, v6
    v_sub_f32 v57, v57, v6
    v_sub_f32 v58, v58, v6
    v_sub_f32 v59, v59, v6
    v_mul_f32 v52, 0x3fb8aa3b, v52
    v_mul_f32 v53, 0x3fb8aa3b, v53
    v_mul_f32 v54, 0x3fb8aa3b, v54
    v_mul_f32 v55, 0x3fb8aa3b, v55
    v_mul_f32 v56, 0x3fb8aa3b, v56
    v_mul_f32 v57, 0x3fb8aa3b, v57
    v_mul_f32 v58, 0x3fb8aa3b, v58
    v_mul_f32 v59, 0x3fb8aa3b, v59
    v_exp_f32 v52, v52
    v_exp_f32 v53, v53
    v_exp_f32 v54, v54
    v_exp_f32 v55, v55
    v_exp_f32 v56, v56
    v_exp_f32 v57, v57
    v_exp_f32 v58, v58
    v_exp_f32 v59, v59
    v_add_f32 v7, v7, v52
    v_add_f32 v7, v7, v53
    v_add_f32 v7, v7, v54
    v_add_f32 v7, v7, v55
    v_add_f32 v7, v7, v56
    v_add_f32 v7, v7, v57
    v_add_f32 v7, v7, v58
    v_add_f32 v7, v7, v59
    v_cvt_pk_bf16_f32 v52, v52, v52
    v_cvt_pk_bf16_f32 v53, v53, v53
    v_cvt_pk_bf16_f32 v54, v54, v54
    v_cvt_pk_bf16_f32 v55, v55, v55
    v_cvt_pk_bf16_f32 v56, v56, v56
    v_cvt_pk_bf16_f32 v57, v57, v57
    v_cvt_pk_bf16_f32 v58, v58, v58
    v_cvt_pk_bf16_f32 v59, v59, v59
    s_waitcnt lgkmcnt(0)
    v_cmp_lt_i32 vcc, 2, v78
    v_mov_b32 v79, 73
    ds_write_b32 v76, v79 offset:16384
    ds_read_b32 v78, v77 offset:256
    s_waitcnt vmcnt(5)
    s_cbranch_vccnz L_w147
    s_waitcnt vmcnt(4)
L_w147:
    buffer_load_dwordx4 v[120:123], v2, s[12:15], s28 offen nt
    s_xor_b32 s28, s26, 0x10800
    v_sub_f32 v60, v60, v6
    v_sub_f32 v61, v61, v6
    v_sub_f32 v62, v62, v6
    v_sub_f32 v63, v63, v6
    v_sub_f32 v64, v64, v6
    v_sub_f32 v65, v65, v6
    v_sub_f32 v66, v66, v6
    v_sub_f32 v67, v67, v6
    v_mul_f32 v60, 0x3fb8aa3b, v60
    v_mul_f32 v61, 0x3fb8aa3b, v61
    v_mul_f32 v62, 0x3fb8aa3b, v62
    v_mul_f32 v63, 0x3fb8aa3b, v63
    v_mul_f32 v64, 0x3fb8aa3b, v64
    v_mul_f32 v65, 0x3fb8aa3b, v65
    v_mul_f32 v66, 0x3fb8aa3b, v66
    v_mul_f32 v67, 0x3fb8aa3b, v67
    v_exp_f32 v60, v60
    v_exp_f32 v61, v61
    v_exp_f32 v62, v62
    v_exp_f32 v63, v63
    v_exp_f32 v64, v64
    v_exp_f32 v65, v65
    v_exp_f32 v66, v66
    v_exp_f32 v67, v67
    v_add_f32 v7, v7, v60
    v_add_f32 v7, v7, v61
    v_add_f32 v7, v7, v62
    v_add_f32 v7, v7, v63
    v_add_f32 v7, v7, v64
    v_add_f32 v7, v7, v65
    v_add_f32 v7, v7, v66
    v_add_f32 v7, v7, v67
    v_cvt_pk_bf16_f32 v60, v60, v60
    v_cvt_pk_bf16_f32 v61, v61, v61
    v_cvt_pk_bf16_f32 v62, v62, v62
    v_cvt_pk_bf16_f32 v63, v63, v63
    v_cvt_pk_bf16_f32 v64, v64, v64
    v_cvt_pk_bf16_f32 v65, v65, v65
    v_cvt_pk_bf16_f32 v66, v66, v66
    v_cvt_pk_bf16_f32 v67, v67, v67
    s_waitcnt vmcnt(5)
    s_cbranch_vccnz L_w148
    s_waitcnt vmcnt(4)
L_w148:
    buffer_load_dwordx4 v[124:127], v2, s[12:15], s28 offen nt
    s_xor_b32 s28, s26, 0x90c00
    v_sub_f32 v68, v68, v6
    v_sub_f32 v69, v69, v6
    v_sub_f32 v70, v70, v6
    v_sub_f32 v71, v71, v6
    v_sub_f32 v72, v72, v6
    v_sub_f32 v73, v73, v6
    v_sub_f32 v74, v74, v6
    v_sub_f32 v75, v75, v6
    v_mul_f32 v68, 0x3fb8aa3b, v68
    v_mul_f32 v69, 0x3fb8aa3b, v69
    v_mul_f32 v70, 0x3fb8aa3b, v70
    v_mul_f32 v71, 0x3fb8aa3b, v71
    v_mul_f32 v72, 0x3fb8aa3b, v72
    v_mul_f32 v73, 0x3fb8aa3b, v73
    v_mul_f32 v74, 0x3fb8aa3b, v74
    v_mul_f32 v75, 0x3fb8aa3b, v75
    v_exp_f32 v68, v68
    v_exp_f32 v69, v69
    v_exp_f32 v70, v70
    v_exp_f32 v71, v71
    v_exp_f32 v72, v72
    v_exp_f32 v73, v73
    v_exp_f32 v74, v74
    v_exp_f32 v75, v75
    v_add_f32 v7, v7, v68
    v_add_f32 v7, v7, v69
    v_add_f32 v7, v7, v70
    v_add_f32 v7, v7, v71
    v_add_f32 v7, v7, v72
    v_add_f32 v7, v7, v73
    v_add_f32 v7, v7, v74
    v_add_f32 v7, v7, v75
    v_cvt_pk_bf16_f32 v68, v68, v68
    v_cvt_pk_bf16_f32 v69, v69, v69
    v_cvt_pk_bf16_f32 v70, v70, v70
    v_cvt_pk_bf16_f32 v71, v71, v71
    v_cvt_pk_bf16_f32 v72, v72, v72
    v_cvt_pk_bf16_f32 v73, v73, v73
    v_cvt_pk_bf16_f32 v74, v74, v74
    v_cvt_pk_bf16_f32 v75, v75, v75
    s_waitcnt lgkmcnt(0)
    v_cmp_lt_i32 vcc, 1, v78
    v_mov_b32 v79, 74
    ds_write_b32 v76, v79 offset:16384
    ds_read_b32 v78, v77 offset:256
    s_waitcnt vmcnt(5)
    s_cbranch_vccnz L_w149
    s_waitcnt vmcnt(4)
L_w149:
    buffer_load_dwordx4 v[128:131], v2, s[12:15], s28 offen nt
    s_xor_b32 s28, s26, 0x14000
    v_add_f32_dpp v7, v7, v7 quad_perm:[1,0,3,2] row_mask:0xf bank_mask:0xf
    s_nop 1
    v_add_f32_dpp v7, v7, v7 quad_perm:[2,3,0,1] row_mask:0xf bank_mask:0xf
    v_mov_b32 v3, v7
    s_nop 1
    v_permlane16_swap_b32 v3, v7
    v_add_f32 v7, v7, v3
    v_mov_b32 v3, v7
    s_nop 1
    v_permlane32_swap_b32 v3, v7
    v_add_f32 v7, v7, v3
    v_lshlrev_b32 v3, 1, v0
    s_lshl_b32 s29, s3, 5
    v_add_u32 v3, s29, v3
    s_mov_b64 exec, 0x1111
    ds_write_b64 v3, v[6:7] offset:64
    s_mov_b64 exec, -1
L_pad21:
    s_cmp_eq_u32 s51, 1
    s_cbranch_scc1 L_pad22
    s_waitcnt vmcnt(5)
    s_cbranch_vccnz L_w150
    s_waitcnt vmcnt(4)
L_w150:
    buffer_load_dwordx4 v[132:135], v2, s[12:15], s28 offen nt
    s_xor_b32 s28, s26, 0x94400
    v_and_b32_dpp v32, v44, v4 quad_perm:[0,0,0,0] row_mask:0xf bank_mask:0xf
    v_and_b32_dpp v33, v44, v5 quad_perm:[0,0,0,0] row_mask:0xf bank_mask:0xf
    v_and_b32_dpp v34, v44, v4 quad_perm:[1,1,1,1] row_mask:0xf bank_mask:0xf
    v_and_b32_dpp v35, v44, v5 quad_perm:[1,1,1,1] row_mask:0xf bank_mask:0xf
    v_mfma_f32_16x16x16_bf16 v[36:39], v[32:33], v[84:85], v[36:39]
    v_mfma_f32_16x16x16_bf16 v[40:43], v[32:33], v[86:87], v[40:43]
    v_mfma_f32_16x16x16_bf16 v[36:39], v[34:35], v[88:89], v[36:39]
    v_mfma_f32_16x16x16_bf16 v[40:43], v[34:35], v[90:91], v[40:43]
    s_waitcnt lgkmcnt(0)
    v_cmp_lt_i32 vcc, 3, v78
    v_mov_b32 v79, 75
    ds_write_b32 v76, v79 offset:16384
    ds_read_b32 v78, v77 offset:256
    s_waitcnt vmcnt(5)
    s_cbranch_vccnz L_w151
    s_waitcnt vmcnt(4)
L_w151:
    buffer_load_dwordx4 v[136:139], v2, s[12:15], s28 offen nt
    s_xor_b32 s28, s26, 0x14800
    v_and_b32_dpp v32, v44, v4 quad_perm:[2,2,2,2] row_mask:0xf bank_mask:0xf
    v_and_b32_dpp v33, v44, v5 quad_perm:[2,2,2,2] row_mask:0xf bank_mask:0xf
    v_and_b32_dpp v34, v44, v4 quad_perm:[3,3,3,3] row_mask:0xf bank_mask:0xf
    v_and_b32_dpp v35, v44, v5 quad_perm:[3,3,3,3] row_mask:0xf bank_mask:0xf
    v_mfma_f32_16x16x16_bf16 v[36:39], v[32:33], v[92:93], v[36:39]
    v_mfma_f32_16x16x16_bf16 v[40:43], v[32:33], v[94:95], v[40:43]
    v_mfma_f32_16x16x16_bf16 v[36:39], v[34:35], v[96:97], v[36:39]
    v_mfma_f32_16x16x16_bf16 v[40:43], v[34:35], v[98:99], v[40:43]
    s_waitcnt vmcnt(5)
    s_cbranch_vccnz L_w152
    s_waitcnt vmcnt(4)
L_w152:
    buffer_load_dwordx4 v[140:143], v2, s[12:15], s28 offen nt
    s_xor_b32 s28, s26, 0x94c00
    v_and_b32_dpp v32, v45, v4 quad_perm:[0,0,0,0] row_mask:0xf bank_mask:0xf
    v_and_b32_dpp v33, v45, v5 quad_perm:[0,0,0,0] row_mask:0xf bank_mask:0xf
    v_and_b32_dpp v34, v45, v4 quad_perm:[1,1,1,1] row_mask:0xf bank_mask:0xf
    v_and_b32_dpp v35, v45, v5 quad_perm:[1,1,1,1] row_mask:0xf bank_mask:0xf
    v_mfma_f32_16x16x16_bf16 v[36:39], v[32:33], v[100:101], v[36:39]
    v_mfma_f32_16x16x16_bf16 v[40:43], v[32:33], v[102:103], v[40:43]
    v_mfma_f32_16x16x16_bf16 v[36:39], v[34:35], v[104:105], v[36:39]
    v_mfma_f32_16x16x16_bf16 v[40:43], v[34:35], v[106:107], v[40:43]
    s_waitcnt lgkmcnt(0)
    v_cmp_lt_i32 vcc, 0, v78
    v_mov_b32 v79, 76
    ds_write_b32 v76, v79 offset:16384
    ds_read_b32 v78, v77 offset:256
    s_waitcnt vmcnt(5)
    s_cbranch_vccnz L_w153
    s_waitcnt vmcnt(4)
L_w153:
    buffer_load_dwordx4 v[144:147], v2, s[12:15], s28 offen nt
    s_xor_b32 s28, s26, 0x20400
    v_and_b32_dpp v32, v45, v4 quad_perm:[2,2,2,2] row_mask:0xf bank_mask:0xf
    v_and_b32_dpp v33, v45, v5 quad_perm:[2,2,2,2] row_mask:0xf bank_mask:0xf
    v_and_b32_dpp v34, v45, v4 quad_perm:[3,3,3,3] row_mask:0xf bank_mask:0xf
    v_and_b32_dpp v35, v45, v5 quad_perm:[3,3,3,3] row_mask:0xf bank_mask:0xf
    v_mfma_f32_16x16x16_bf16 v[36:39], v[32:33], v[108:109], v[36:39]
    v_mfma_f32_16x16x16_bf16 v[40:43], v[32:33], v[110:111], v[40:43]
    v_mfma_f32_16x16x16_bf16 v[36:39], v[34:35], v[112:113], v[36:39]
    v_mfma_f32_16x16x16_bf16 v[40:43], v[34:35], v[114:115], v[40:43]
    s_waitcnt vmcnt(5)
    s_cbranch_vccnz L_w154
    s_waitcnt vmcnt(4)
L_w154:
    buffer_load_dwordx4 v[148:151], v2, s[12:15], s28 offen nt
    s_xor_b32 s28, s26, 0xa0000
    v_and_b32_dpp v32, v46, v4 quad_perm:[0,0,0,0] row_mask:0xf bank_mask:0xf
    v_and_b32_dpp v33, v46, v5 quad_perm:[0,0,0,0] row_mask:0xf bank_mask:0xf
    v_and_b32_dpp v34, v46, v4 quad_perm:[1,1,1,1] row_mask:0xf bank_mask:0xf
    v_and_b32_dpp v35, v46, v5 quad_perm:[1,1,1,1] row_mask:0xf bank_mask:0xf
    v_mfma_f32_16x16x16_bf16 v[36:39], v[32:33], v[116:117], v[36:39]
    v_mfma_f32_16x16x16_bf16 v[40:43], v[32:33], v[118:119], v[40:43]
    v_mfma_f32_16x16x16_bf16 v[36:39], v[34:35], v[120:121], v[36:39]
    v_mfma_f32_16x16x16_bf16 v[40:43], v[34:35], v[122:123], v[40:43]
    s_waitcnt lgkmcnt(0)
    v_cmp_lt_i32 vcc, 2, v78
    v_mov_b32 v79, 77
    ds_write_b32 v76, v79 offset:16384
    ds_read_b32 v78, v77 offset:256
    s_waitcnt vmcnt(5)
    s_cbranch_vccnz L_w155
    s_waitcnt vmcnt(4)
L_w155:
    buffer_load_dwordx4 v[152:155], v2, s[12:15], s28 offen nt
    s_xor_b32 s28, s26, 0x20c00
    v_and_b32_dpp v32, v46, v4 quad_perm:[2,2,2,2] row_mask:0xf bank_mask:0xf
    v_and_b32_dpp v33, v46, v5 quad_perm:[2,2,2,2] row_mask:0xf bank_mask:0xf
    v_and_b32_dpp v34, v46, v4 quad_perm:[3,3,3,3] row_mask:0xf bank_mask:0xf
    v_and_b32_dpp v35, v46, v5 quad_perm:[3,3,3,3] row_mask:0xf bank_mask:0xf
    v_mfma_f32_16x16x16_bf16 v[36:39], v[32:33], v[124:125], v[36:39]
    v_mfma_f32_16x16x16_bf16 v[40:43], v[32:33], v[126:127], v[40:43]
    v_mfma_f32_16x16x16_bf16 v[36:39], v[34:35], v[128:129], v[36:39]
    v_mfma_f32_16x16x16_bf16 v[40:43], v[34:35], v[130:131], v[40:43]
    s_waitcnt vmcnt(5)
    s_cbranch_vccnz L_w156
    s_waitcnt vmcnt(4)
L_w156:
    buffer_load_dwordx4 v[156:159], v2, s[12:15], s28 offen nt
    s_xor_b32 s28, s26, 0xa0800
    v_and_b32_dpp v32, v47, v4 quad_perm:[0,0,0,0] row_mask:0xf bank_mask:0xf
    v_and_b32_dpp v33, v47, v5 quad_perm:[0,0,0,0] row_mask:0xf bank_mask:0xf
    s_nop 1
    v_mfma_f32_16x16x16_bf16 v[36:39], v[32:33], v[132:133], v[36:39]
    v_mfma_f32_16x16x16_bf16 v[40:43], v[32:33], v[134:135], v[40:43]
    s_waitcnt lgkmcnt(0)
    v_cmp_lt_i32 vcc, 1, v78
    v_mov_b32 v79, 78
    ds_write_b32 v76, v79 offset:16384
    ds_read_b32 v78, v77 offset:256
    s_waitcnt vmcnt(5)
    s_cbranch_vccnz L_w157
    s_waitcnt vmcnt(4)
L_w157:
    buffer_load_dwordx4 v[160:163], v2, s[12:15], s28 offen nt
    s_xor_b32 s28, s26, 0x24400
    v_and_b32_dpp v34, v47, v4 quad_perm:[1,1,1,1] row_mask:0xf bank_mask:0xf
    v_and_b32_dpp v35, v47, v5 quad_perm:[1,1,1,1] row_mask:0xf bank_mask:0xf
    s_nop 1
    v_mfma_f32_16x16x16_bf16 v[36:39], v[34:35], v[136:137], v[36:39]
    v_mfma_f32_16x16x16_bf16 v[40:43], v[34:35], v[138:139], v[40:43]
    s_waitcnt vmcnt(5)
    s_cbranch_vccnz L_w158
    s_waitcnt vmcnt(4)
L_w158:
    buffer_load_dwordx4 v[164:167], v2, s[12:15], s28 offen nt
    s_xor_b32 s28, s26, 0xa4000
    v_and_b32_dpp v32, v47, v4 quad_perm:[2,2,2,2] row_mask:0xf bank_mask:0xf
    v_and_b32_dpp v33, v47, v5 quad_perm:[2,2,2,2] row_mask:0xf bank_mask:0xf
    s_nop 1
    v_mfma_f32_16x16x16_bf16 v[36:39], v[32:33], v[140:141], v[36:39]
    v_mfma_f32_16x16x16_bf16 v[40:43], v[32:33], v[142:143], v[40:43]
    s_waitcnt lgkmcnt(0)
    v_cmp_lt_i32 vcc, 3, v78
    v_mov_b32 v79, 79
    ds_write_b32 v76, v79 offset:16384
    ds_read_b32 v78, v77 offset:256
    s_waitcnt vmcnt(5)
    s_cbranch_vccnz L_w159
    s_waitcnt vmcnt(4)
L_w159:
    buffer_load_dwordx4 v[168:171], v2, s[12:15], s28 offen nt
    s_xor_b32 s28, s26, 0x24c00
    v_and_b32_dpp v34, v47, v4 quad_perm:[3,3,3,3] row_mask:0xf bank_mask:0xf
    v_and_b32_dpp v35, v47, v5 quad_perm:[3,3,3,3] row_mask:0xf bank_mask:0xf
    s_nop 1
    v_mfma_f32_16x16x16_bf16 v[36:39], v[34:35], v[144:145], v[36:39]
    v_mfma_f32_16x16x16_bf16 v[40:43], v[34:35], v[146:147], v[40:43]
    s_waitcnt vmcnt(5)
    s_cbranch_vccnz L_w160
    s_waitcnt vmcnt(4)
L_w160:
    buffer_load_dwordx4 v[172:175], v2, s[12:15], s28 offen nt
    s_xor_b32 s28, s26, 0xa4800
L_pad22:
    s_cmp_eq_u32 s51, 1
    s_cbranch_scc1 L_pad23
    v_and_b32_dpp v32, v48, v4 quad_perm:[0,0,0,0] row_mask:0xf bank_mask:0xf
    v_and_b32_dpp v33, v48, v5 quad_perm:[0,0,0,0] row_mask:0xf bank_mask:0xf
    s_nop 1
    v_mfma_f32_16x16x16_bf16 v[36:39], v[32:33], v[148:149], v[36:39]
    v_mfma_f32_16x16x16_bf16 v[40:43], v[32:33], v[150:151], v[40:43]
    s_waitcnt lgkmcnt(0)
    v_cmp_lt_i32 vcc, 0, v78
    v_mov_b32 v79, 80
    ds_write_b32 v76, v79 offset:16384
    ds_read_b32 v78, v77 offset:256
    s_waitcnt vmcnt(5)
    s_cbranch_vccnz L_w161
    s_waitcnt vmcnt(4)
L_w161:
    buffer_load_dwordx4 v[176:179], v2, s[12:15], s28 offen nt
    s_xor_b32 s28, s26, 0x30400
    v_and_b32_dpp v34, v48, v4 quad_perm:[1,1,1,1] row_mask:0xf bank_mask:0xf
    v_and_b32_dpp v35, v48, v5 quad_perm:[1,1,1,1] row_mask:0xf bank_mask:0xf
    s_nop 1
    v_mfma_f32_16x16x16_bf16 v[36:39], v[34:35], v[152:153], v[36:39]
    v_mfma_f32_16x16x16_bf16 v[40:43], v[34:35], v[154:155], v[40:43]
    s_waitcnt vmcnt(5)
    s_cbranch_vccnz L_w162
    s_waitcnt vmcnt(4)
L_w162:
    buffer_load_dwordx4 v[180:183], v2, s[12:15], s28 offen nt
    s_xor_b32 s28, s26, 0xb0000
    v_and_b32_dpp v32, v48, v4 quad_perm:[2,2,2,2] row_mask:0xf bank_mask:0xf
    v_and_b32_dpp v33, v48, v5 quad_perm:[2,2,2,2] row_mask:0xf bank_mask:0xf
    s_nop 1
    v_mfma_f32_16x16x16_bf16 v[36:39], v[32:33], v[156:157], v[36:39]
    v_mfma_f32_16x16x16_bf16 v[40:43], v[32:33], v[158:159], v[40:43]
    s_waitcnt lgkmcnt(0)
    v_cmp_lt_i32 vcc, 2, v78
    v_mov_b32 v79, 81
    ds_write_b32 v76, v79 offset:16384
    ds_read_b32 v78, v77 offset:256
    s_waitcnt vmcnt(5)
    s_cbranch_vccnz L_w163
    s_waitcnt vmcnt(4)
L_w163:
    buffer_load_dwordx4 v[184:187], v2, s[12:15], s28 offen nt
    s_xor_b32 s28, s26, 0x30c00
    v_and_b32_dpp v34, v48, v4 quad_perm:[3,3,3,3] row_mask:0xf bank_mask:0xf
    v_and_b32_dpp v35, v48, v5 quad_perm:[3,3,3,3] row_mask:0xf bank_mask:0xf
    s_nop 1
    v_mfma_f32_16x16x16_bf16 v[36:39], v[34:35], v[160:161], v[36:39]
    v_mfma_f32_16x16x16_bf16 v[40:43], v[34:35], v[162:163], v[40:43]
    s_waitcnt vmcnt(5)
    s_cbranch_vccnz L_w164
    s_waitcnt vmcnt(4)
L_w164:
    buffer_load_dwordx4 v[188:191], v2, s[12:15], s28 offen nt
    s_xor_b32 s28, s26, 0xb0800
    v_and_b32_dpp v32, v49, v4 quad_perm:[0,0,0,0] row_mask:0xf bank_mask:0xf
    v_and_b32_dpp v33, v49, v5 quad_perm:[0,0,0,0] row_mask:0xf bank_mask:0xf
    s_nop 1
    v_mfma_f32_16x16x16_bf16 v[36:39], v[32:33], v[164:165], v[36:39]
    v_mfma_f32_16x16x16_bf16 v[40:43], v[32:33], v[166:167], v[40:43]
    s_waitcnt lgkmcnt(0)
    v_cmp_lt_i32 vcc, 1, v78
    v_mov_b32 v79, 82
    ds_write_b32 v76, v79 offset:16384
    ds_read_b32 v78, v77 offset:256
    s_waitcnt vmcnt(5)
    s_cbranch_vccnz L_w165
    s_waitcnt vmcnt(4)
L_w165:
    buffer_load_dwordx4 v[192:195], v2, s[12:15], s28 offen nt
    s_xor_b32 s28, s26, 0x34400
    v_and_b32_dpp v34, v49, v4 quad_perm:[1,1,1,1] row_mask:0xf bank_mask:0xf
    v_and_b32_dpp v35, v49, v5 quad_perm:[1,1,1,1] row_mask:0xf bank_mask:0xf
    s_nop 1
    v_mfma_f32_16x16x16_bf16 v[36:39], v[34:35], v[168:169], v[36:39]
    v_mfma_f32_16x16x16_bf16 v[40:43], v[34:35], v[170:171], v[40:43]
    s_waitcnt vmcnt(5)
    s_cbranch_vccnz L_w166
    s_waitcnt vmcnt(4)
L_w166:
    buffer_load_dwordx4 v[196:199], v2, s[12:15], s28 offen nt
    s_xor_b32 s28, s26, 0xb4000
    v_and_b32_dpp v32, v49, v4 quad_perm:[2,2,2,2] row_mask:0xf bank_mask:0xf
    v_and_b32_dpp v33, v49, v5 quad_perm:[2,2,2,2] row_mask:0xf bank_mask:0xf
    s_nop 1
    v_mfma_f32_16x16x16_bf16 v[36:39], v[32:33], v[172:173], v[36:39]
    v_mfma_f32_16x16x16_bf16 v[40:43], v[32:33], v[174:175], v[40:43]
    s_waitcnt lgkmcnt(0)
    v_cmp_lt_i32 vcc, 3, v78
    v_mov_b32 v79, 83
    ds_write_b32 v76, v79 offset:16384
    ds_read_b32 v78, v77 offset:256
    s_waitcnt vmcnt(5)
    s_cbranch_vccnz L_w167
    s_waitcnt vmcnt(4)
L_w167:
    buffer_load_dwordx4 v[200:203], v2, s[12:15], s28 offen nt
    s_xor_b32 s28, s26, 0x34c00
    v_and_b32_dpp v34, v49, v4 quad_perm:[3,3,3,3] row_mask:0xf bank_mask:0xf
    v_and_b32_dpp v35, v49, v5 quad_perm:[3,3,3,3] row_mask:0xf bank_mask:0xf
    s_nop 1
    v_mfma_f32_16x16x16_bf16 v[36:39], v[34:35], v[176:177], v[36:39]
    v_mfma_f32_16x16x16_bf16 v[40:43], v[34:35], v[178:179], v[40:43]
    s_waitcnt vmcnt(5)
    s_cbranch_vccnz L_w168
    s_waitcnt vmcnt(4)
L_w168:
    buffer_load_dwordx4 v[204:207], v2, s[12:15], s28 offen nt
    s_xor_b32 s28, s26, 0xb4800
    v_and_b32_dpp v32, v50, v4 quad_perm:[0,0,0,0] row_mask:0xf bank_mask:0xf
    v_and_b32_dpp v33, v50, v5 quad_perm:[0,0,0,0] row_mask:0xf bank_mask:0xf
    s_nop 1
    v_mfma_f32_16x16x16_bf16 v[36:39], v[32:33], v[180:181], v[36:39]
    v_mfma_f32_16x16x16_bf16 v[40:43], v[32:33], v[182:183], v[40:43]
    s_waitcnt lgkmcnt(0)
    v_cmp_lt_i32 vcc, 0, v78
    v_mov_b32 v79, 84
    ds_write_b32 v76, v79 offset:16384
    ds_read_b32 v78, v77 offset:256
    s_waitcnt vmcnt(5)
    s_cbranch_vccnz L_w169
    s_waitcnt vmcnt(4)
L_w169:
    buffer_load_dwordx4 v[208:211], v2, s[12:15], s28 offen nt
    s_xor_b32 s28, s26, 0x101000
    v_and_b32_dpp v34, v50, v4 quad_perm:[1,1,1,1] row_mask:0xf bank_mask:0xf
    v_and_b32_dpp v35, v50, v5 quad_perm:[1,1,1,1] row_mask:0xf bank_mask:0xf
    s_nop 1
    v_mfma_f32_16x16x16_bf16 v[36:39], v[34:35], v[184:185], v[36:39]
    v_mfma_f32_16x16x16_bf16 v[40:43], v[34:35], v[186:187], v[40:43]
    s_waitcnt vmcnt(5)
    s_cbranch_vccnz L_w170
    s_waitcnt vmcnt(4)
L_w170:
    buffer_load_dwordx4 v[212:215], v2, s[12:15], s28 offen nt
    s_xor_b32 s28, s26, 0x181400
    v_and_b32_dpp v32, v50, v4 quad_perm:[2,2,2,2] row_mask:0xf bank_mask:0xf
    v_and_b32_dpp v33, v50, v5 quad_perm:[2,2,2,2] row_mask:0xf bank_mask:0xf
    s_nop 1
    v_mfma_f32_16x16x16_bf16 v[36:39], v[32:33], v[188:189], v[36:39]
    v_mfma_f32_16x16x16_bf16 v[40:43], v[32:33], v[190:191], v[40:43]
    s_waitcnt lgkmcnt(0)
    v_cmp_lt_i32 vcc, 2, v78
    v_mov_b32 v79, 85
    ds_write_b32 v76, v79 offset:16384
    ds_read_b32 v78, v77 offset:256
    s_waitcnt vmcnt(5)
    s_cbranch_vccnz L_w171
    s_waitcnt vmcnt(4)
L_w171:
    buffer_load_dwordx4 v[80:83], v2, s[12:15], s28 offen nt
    s_xor_b32 s28, s26, 0x101800
    v_and_b32_dpp v34, v50, v4 quad_perm:[3,3,3,3] row_mask:0xf bank_mask:0xf
    v_and_b32_dpp v35, v50, v5 quad_perm:[3,3,3,3] row_mask:0xf bank_mask:0xf
    s_nop 1
    v_mfma_f32_16x16x16_bf16 v[36:39], v[34:35], v[192:193], v[36:39]
    v_mfma_f32_16x16x16_bf16 v[40:43], v[34:35], v[194:195], v[40:43]
    s_waitcnt vmcnt(5)
    s_cbranch_vccnz L_w172
    s_waitcnt vmcnt(4)
L_w172:
    buffer_load_dwordx4 v[84:87], v2, s[12:15], s28 offen nt
    s_xor_b32 s28, s26, 0x181c00
    v_and_b32_dpp v32, v51, v4 quad_perm:[0,0,0,0] row_mask:0xf bank_mask:0xf
    v_and_b32_dpp v33, v51, v5 quad_perm:[0,0,0,0] row_mask:0xf bank_mask:0xf
    s_nop 1
    v_mfma_f32_16x16x16_bf16 v[36:39], v[32:33], v[196:197], v[36:39]
    v_mfma_f32_16x16x16_bf16 v[40:43], v[32:33], v[198:199], v[40:43]
    s_waitcnt lgkmcnt(0)
    v_cmp_lt_i32 vcc, 1, v78
    v_mov_b32 v79, 86
    ds_write_b32 v76, v79 offset:16384
    ds_read_b32 v78, v77 offset:256
L_pad23:
    s_cmp_eq_u32 s51, 1
    s_cbranch_scc1 L_pad24
    s_waitcnt vmcnt(5)
    s_cbranch_vccnz L_w173
    s_waitcnt vmcnt(4)
L_w173:
    buffer_load_dwordx4 v[88:91], v2, s[12:15], s28 offen nt
    s_xor_b32 s28, s26, 0x105000
    v_and_b32_dpp v34, v51, v4 quad_perm:[1,1,1,1] row_mask:0xf bank_mask:0xf
    v_and_b32_dpp v35, v51, v5 quad_perm:[1,1,1,1] row_mask:0xf bank_mask:0xf
    s_nop 1
    v_mfma_f32_16x16x16_bf16 v[36:39], v[34:35], v[200:201], v[36:39]
    v_mfma_f32_16x16x16_bf16 v[40:43], v[34:35], v[202:203], v[40:43]
    s_waitcnt vmcnt(5)
    s_cbranch_vccnz L_w174
    s_waitcnt vmcnt(4)
L_w174:
    buffer_load_dwordx4 v[92:95], v2, s[12:15], s28 offen nt
    s_xor_b32 s28, s26, 0x185400
    v_and_b32_dpp v32, v51, v4 quad_perm:[2,2,2,2] row_mask:0xf bank_mask:0xf
    v_and_b32_dpp v33, v51, v5 quad_perm:[2,2,2,2] row_mask:0xf bank_mask:0xf
    s_nop 1
    v_mfma_f32_16x16x16_bf16 v[36:39], v[32:33], v[204:205], v[36:39]
    v_mfma_f32_16x16x16_bf16 v[40:43], v[32:33], v[206:207], v[40:43]
    s_waitcnt lgkmcnt(0)
    v_cmp_lt_i32 vcc, 3, v78
    v_mov_b32 v79, 87
    ds_write_b32 v76, v79 offset:16384
    ds_read_b32 v78, v77 offset:256
    s_waitcnt vmcnt(5)
    s_cbranch_vccnz L_w175
    s_waitcnt vmcnt(4)
L_w175:
    buffer_load_dwordx4 v[96:99], v2, s[12:15], s28 offen nt
    s_xor_b32 s28, s26, 0x105800
    v_and_b32_dpp v34, v51, v4 quad_perm:[3,3,3,3] row_mask:0xf bank_mask:0xf
    v_and_b32_dpp v35, v51, v5 quad_perm:[3,3,3,3] row_mask:0xf bank_mask:0xf
    s_nop 1
    v_mfma_f32_16x16x16_bf16 v[36:39], v[34:35], v[208:209], v[36:39]
    v_mfma_f32_16x16x16_bf16 v[40:43], v[34:35], v[210:211], v[40:43]
    s_waitcnt vmcnt(5)
    s_cbranch_vccnz L_w176
    s_waitcnt vmcnt(4)
L_w176:
    buffer_load_dwordx4 v[100:103], v2, s[12:15], s28 offen nt
    s_xor_b32 s28, s26, 0x185c00
    v_and_b32_dpp v32, v52, v4 quad_perm:[0,0,0,0] row_mask:0xf bank_mask:0xf
    v_and_b32_dpp v33, v52, v5 quad_perm:[0,0,0,0] row_mask:0xf bank_mask:0xf
    s_nop 1
    v_mfma_f32_16x16x16_bf16 v[36:39], v[32:33], v[212:213], v[36:39]
    v_mfma_f32_16x16x16_bf16 v[40:43], v[32:33], v[214:215], v[40:43]
    s_waitcnt lgkmcnt(0)
    v_cmp_lt_i32 vcc, 0, v78
    v_mov_b32 v79, 88
    ds_write_b32 v76, v79 offset:16384
    ds_read_b32 v78, v77 offset:256
    s_waitcnt vmcnt(5)
    s_cbranch_vccnz L_w177
    s_waitcnt vmcnt(4)
L_w177:
    buffer_load_dwordx4 v[104:107], v2, s[12:15], s28 offen nt
    s_xor_b32 s28, s26, 0x111000
    v_and_b32_dpp v34, v52, v4 quad_perm:[1,1,1,1] row_mask:0xf bank_mask:0xf
    v_and_b32_dpp v35, v52, v5 quad_perm:[1,1,1,1] row_mask:0xf bank_mask:0xf
    s_nop 1
    v_mfma_f32_16x16x16_bf16 v[36:39], v[34:35], v[80:81], v[36:39]
    v_mfma_f32_16x16x16_bf16 v[40:43], v[34:35], v[82:83], v[40:43]
    s_waitcnt vmcnt(5)
    s_cbranch_vccnz L_w178
    s_waitcnt vmcnt(4)
L_w178:
    buffer_load_dwordx4 v[108:111], v2, s[12:15], s28 offen nt
    s_xor_b32 s28, s26, 0x191400
    v_and_b32_dpp v32, v52, v4 quad_perm:[2,2,2,2] row_mask:0xf bank_mask:0xf
    v_and_b32_dpp v33, v52, v5 quad_perm:[2,2,2,2] row_mask:0xf bank_mask:0xf
    s_nop 1
    v_mfma_f32_16x16x16_bf16 v[36:39], v[32:33], v[84:85], v[36:39]
    v_mfma_f32_16x16x16_bf16 v[40:43], v[32:33], v[86:87], v[40:43]
    s_waitcnt lgkmcnt(0)
    v_cmp_lt_i32 vcc, 2, v78
    v_mov_b32 v79, 89
    ds_write_b32 v76, v79 offset:16384
    ds_read_b32 v78, v77 offset:256
    s_waitcnt vmcnt(5)
    s_cbranch_vccnz L_w179
    s_waitcnt vmcnt(4)
L_w179:
    buffer_load_dwordx4 v[112:115], v2, s[12:15], s28 offen nt
    s_xor_b32 s28, s26, 0x111800
    v_and_b32_dpp v34, v52, v4 quad_perm:[3,3,3,3] row_mask:0xf bank_mask:0xf
    v_and_b32_dpp v35, v52, v5 quad_perm:[3,3,3,3] row_mask:0xf bank_mask:0xf
    s_nop 1
    v_mfma_f32_16x16x16_bf16 v[36:39], v[34:35], v[88:89], v[36:39]
    v_mfma_f32_16x16x16_bf16 v[40:43], v[34:35], v[90:91], v[40:43]
    s_waitcnt vmcnt(5)
    s_cbranch_vccnz L_w180
    s_waitcnt vmcnt(4)
L_w180:
    buffer_load_dwordx4 v[116:119], v2, s[12:15], s28 offen nt
    s_xor_b32 s28, s26, 0x191c00
    v_and_b32_dpp v32, v53, v4 quad_perm:[0,0,0,0] row_mask:0xf bank_mask:0xf
    v_and_b32_dpp v33, v53, v5 quad_perm:[0,0,0,0] row_mask:0xf bank_mask:0xf
    s_nop 1
    v_mfma_f32_16x16x16_bf16 v[36:39], v[32:33], v[92:93], v[36:39]
    v_mfma_f32_16x16x16_bf16 v[40:43], v[32:33], v[94:95], v[40:43]
    s_bfe_u32 s37, s36, 0x80000
    s_bfe_u32 s38, s36, 0x80008
    s_bfe_u32 s39, s36, 0x80010
    s_bfe_u32 s40, s36, 0x80018
    s_mov_b32 s34, 0xff00ff00
    s_mov_b32 s35, 0xff00ff00
    v_cndmask_b32 v216, v4, 0, s[34:35]
    v_cndmask_b32 v217, v5, 0, s[34:35]
    v_cndmask_b32 v218, 0, v4, s[34:35]
    v_cndmask_b32 v219, 0, v5, s[34:35]
    v_mov_b32 v228, s36
    v_mov_b32 v229, 0
    v_mov_b32 v230, 0xffffff00
    s_lshr_b32 s49, s2, 3
    s_or_b32 s49, s49, s3
    s_and_b32 s48, s2, 7
    s_lshl_b32 s48, s48, 8
    s_add_u32 s48, s48, 8192
    v_mov_b32 v12, 0
    v_mov_b32 v13, 0
    v_mov_b32 v14, 0
    v_mov_b32 v15, 0
    s_mov_b32 s50, 262144
    s_waitcnt lgkmcnt(0)
    v_cmp_lt_i32 vcc, 1, v78
    v_mov_b32 v79, 90
    ds_write_b32 v76, v79 offset:16384
    ds_read_b32 v78, v77 offset:256
    s_waitcnt vmcnt(5)
    s_cbranch_vccnz L_w181
    s_waitcnt vmcnt(4)
L_w181:
    buffer_load_dwordx4 v[120:123], v2, s[12:15], s28 offen nt
    s_xor_b32 s28, s26, 0x115000
    v_and_b32_dpp v34, v53, v4 quad_perm:[1,1,1,1] row_mask:0xf bank_mask:0xf
    v_and_b32_dpp v35, v53, v5 quad_perm:[1,1,1,1] row_mask:0xf bank_mask:0xf
    s_nop 1
    v_mfma_f32_16x16x16_bf16 v[36:39], v[34:35], v[96:97], v[36:39]
    v_mfma_f32_16x16x16_bf16 v[40:43], v[34:35], v[98:99], v[40:43]
    s_waitcnt vmcnt(5)
    s_cbranch_vccnz L_w182
    s_waitcnt vmcnt(4)
L_w182:
    buffer_load_dwordx4 v[124:127], v2, s[12:15], s28 offen nt
    s_xor_b32 s28, s26, 0x195400
    v_and_b32_dpp v32, v53, v4 quad_perm:[2,2,2,2] row_mask:0xf bank_mask:0xf
    v_and_b32_dpp v33, v53, v5 quad_perm:[2,2,2,2] row_mask:0xf bank_mask:0xf
    s_nop 1
    v_mfma_f32_16x16x16_bf16 v[36:39], v[32:33], v[100:101], v[36:39]
    v_mfma_f32_16x16x16_bf16 v[40:43], v[32:33], v[102:103], v[40:43]
    v_bfe_u32 v246, v0, 2, 1
    v_lshlrev_b32 v226, 18, v246
    v_lshrrev_b32 v246, 3, v0
    v_lshl_add_u32 v226, v246, 11, v226
    v_and_b32 v246, 3, v0
    v_lshl_add_u32 v226, v246, 4, v226
    v_lshrrev_b32 v246, 4, v0
    s_lshr_b32 s31, s42, 3
    s_lshl_b32 s31, s31, 15
    s_and_b32 s29, s42, 7
    s_lshl_b32 s29, s29, 8
    s_add_u32 s31, s31, s29
    s_lshl_b32 s29, s3, 6
    s_add_u32 s31, s31, s29
    s_add_u32 s31, s31, 524288
    s_add_u32 s33, s31, 16384
    s_lshl_b32 s30, s42, 2
    s_add_u32 s30, s30, s3
    s_lshl_b32 s30, s30, 14
    s_lshl_b32 s29, s41, 8
    s_add_u32 s30, s30, s29
    v_and_b32 v231, 15, v0
    v_lshlrev_b32 v231, 4, v231
    v_lshl_add_u32 v231, v246, 10, v231
    s_lshl_b32 s32, s41, 16
    s_lshl_b32 s29, s42, 10
    s_add_u32 s32, s32, s29
    s_add_u32 s32, s32, 1048576
    v_lshlrev_b32 v227, 5, v0
    s_lshl_b32 s29, s3, 11
    v_add_u32 v227, s29, v227
    s_lshl_b32 s29, s3, 10
    v_add_u32 v1, s29, v2
L_pad24:
    s_cmp_eq_u32 s51, 1
    s_cbranch_scc1 L_pad25
    s_waitcnt lgkmcnt(0)
    v_cmp_lt_i32 vcc, 3, v78
    v_mov_b32 v79, 91
    ds_write_b32 v76, v79 offset:16384
    ds_read_b32 v78, v77 offset:256
    s_waitcnt vmcnt(5)
    s_cbranch_vccnz L_w183
    s_waitcnt vmcnt(4)
L_w183:
    buffer_load_dwordx4 v[128:131], v2, s[12:15], s28 offen nt
    s_xor_b32 s28, s26, 0x115800
    v_and_b32_dpp v34, v53, v4 quad_perm:[3,3,3,3] row_mask:0xf bank_mask:0xf
    v_and_b32_dpp v35, v53, v5 quad_perm:[3,3,3,3] row_mask:0xf bank_mask:0xf
    s_nop 1
    v_mfma_f32_16x16x16_bf16 v[36:39], v[34:35], v[104:105], v[36:39]
    v_mfma_f32_16x16x16_bf16 v[40:43], v[34:35], v[106:107], v[40:43]
    s_waitcnt vmcnt(5)
    s_cbranch_vccnz L_w184
    s_waitcnt vmcnt(4)
L_w184:
    buffer_load_dwordx4 v[132:135], v2, s[12:15], s28 offen nt
    s_xor_b32 s28, s26, 0x195c00
    v_and_b32_dpp v32, v54, v4 quad_perm:[0,0,0,0] row_mask:0xf bank_mask:0xf
    v_and_b32_dpp v33, v54, v5 quad_perm:[0,0,0,0] row_mask:0xf bank_mask:0xf
    s_nop 1
    v_mfma_f32_16x16x16_bf16 v[36:39], v[32:33], v[108:109], v[36:39]
    v_mfma_f32_16x16x16_bf16 v[40:43], v[32:33], v[110:111], v[40:43]
    s_waitcnt lgkmcnt(0)
    v_cmp_lt_i32 vcc, 0, v78
    v_mov_b32 v79, 92
    ds_write_b32 v76, v79 offset:16384
    ds_read_b32 v78, v77 offset:256
    s_waitcnt vmcnt(5)
    s_cbranch_vccnz L_w185
    s_waitcnt vmcnt(4)
L_w185:
    buffer_load_dwordx4 v[136:139], v2, s[12:15], s28 offen nt
    s_xor_b32 s28, s26, 0x121400
    v_and_b32_dpp v34, v54, v4 quad_perm:[1,1,1,1] row_mask:0xf bank_mask:0xf
    v_and_b32_dpp v35, v54, v5 quad_perm:[1,1,1,1] row_mask:0xf bank_mask:0xf
    s_nop 1
    v_mfma_f32_16x16x16_bf16 v[36:39], v[34:35], v[112:113], v[36:39]
    v_mfma_f32_16x16x16_bf16 v[40:43], v[34:35], v[114:115], v[40:43]
    s_waitcnt vmcnt(5)
    s_cbranch_vccnz L_w186
    s_waitcnt vmcnt(4)
L_w186:
    buffer_load_dwordx4 v[140:143], v2, s[12:15], s28 offen nt
    s_xor_b32 s28, s26, 0x1a1000
    v_and_b32_dpp v32, v54, v4 quad_perm:[2,2,2,2] row_mask:0xf bank_mask:0xf
    v_and_b32_dpp v33, v54, v5 quad_perm:[2,2,2,2] row_mask:0xf bank_mask:0xf
    s_nop 1
    v_mfma_f32_16x16x16_bf16 v[36:39], v[32:33], v[116:117], v[36:39]
    v_mfma_f32_16x16x16_bf16 v[40:43], v[32:33], v[118:119], v[40:43]
    s_waitcnt lgkmcnt(0)
    v_cmp_lt_i32 vcc, 2, v78
    v_mov_b32 v79, 93
    ds_write_b32 v76, v79 offset:16384
    ds_read_b32 v78, v77 offset:256
    s_waitcnt vmcnt(5)
    s_cbranch_vccnz L_w187
    s_waitcnt vmcnt(4)
L_w187:
    buffer_load_dwordx4 v[144:147], v2, s[12:15], s28 offen nt
    s_xor_b32 s28, s26, 0x121c00
    v_and_b32_dpp v34, v54, v4 quad_perm:[3,3,3,3] row_mask:0xf bank_mask:0xf
    v_and_b32_dpp v35, v54, v5 quad_perm:[3,3,3,3] row_mask:0xf bank_mask:0xf
    s_nop 1
    v_mfma_f32_16x16x16_bf16 v[36:39], v[34:35], v[120:121], v[36:39]
    v_mfma_f32_16x16x16_bf16 v[40:43], v[34:35], v[122:123], v[40:43]
    s_waitcnt vmcnt(5)
    s_cbranch_vccnz L_w188
    s_waitcnt vmcnt(4)
L_w188:
    buffer_load_dwordx4 v[148:151], v2, s[12:15], s28 offen nt
    s_xor_b32 s28, s26, 0x1a1800
    v_and_b32_dpp v32, v55, v4 quad_perm:[0,0,0,0] row_mask:0xf bank_mask:0xf
    v_and_b32_dpp v33, v55, v5 quad_perm:[0,0,0,0] row_mask:0xf bank_mask:0xf
    s_nop 1
    v_mfma_f32_16x16x16_bf16 v[36:39], v[32:33], v[124:125], v[36:39]
    v_mfma_f32_16x16x16_bf16 v[40:43], v[32:33], v[126:127], v[40:43]
    s_waitcnt lgkmcnt(0)
    v_cmp_lt_i32 vcc, 1, v78
    v_mov_b32 v79, 94
    ds_write_b32 v76, v79 offset:16384
    ds_read_b32 v78, v77 offset:256
    s_waitcnt vmcnt(5)
    s_cbranch_vccnz L_w189
    s_waitcnt vmcnt(4)
L_w189:
    buffer_load_dwordx4 v[152:155], v2, s[12:15], s28 offen nt
    s_xor_b32 s28, s26, 0x125400
    v_and_b32_dpp v34, v55, v4 quad_perm:[1,1,1,1] row_mask:0xf bank_mask:0xf
    v_and_b32_dpp v35, v55, v5 quad_perm:[1,1,1,1] row_mask:0xf bank_mask:0xf
    s_nop 1
    v_mfma_f32_16x16x16_bf16 v[36:39], v[34:35], v[128:129], v[36:39]
    v_mfma_f32_16x16x16_bf16 v[40:43], v[34:35], v[130:131], v[40:43]
    s_waitcnt vmcnt(5)
    s_cbranch_vccnz L_w190
    s_waitcnt vmcnt(4)
L_w190:
    buffer_load_dwordx4 v[156:159], v2, s[12:15], s28 offen nt
    s_xor_b32 s28, s26, 0x1a5000
    v_and_b32_dpp v32, v55, v4 quad_perm:[2,2,2,2] row_mask:0xf bank_mask:0xf
    v_and_b32_dpp v33, v55, v5 quad_perm:[2,2,2,2] row_mask:0xf bank_mask:0xf
    s_nop 1
    v_mfma_f32_16x16x16_bf16 v[36:39], v[32:33], v[132:133], v[36:39]
    v_mfma_f32_16x16x16_bf16 v[40:43], v[32:33], v[134:135], v[40:43]
    s_waitcnt lgkmcnt(0)
    v_cmp_lt_i32 vcc, 3, v78
    v_mov_b32 v79, 95
    ds_write_b32 v76, v79 offset:16384
    ds_read_b32 v78, v77 offset:256
    s_waitcnt vmcnt(5)
    s_cbranch_vccnz L_w191
    s_waitcnt vmcnt(4)
L_w191:
    buffer_load_dwordx4 v[160:163], v2, s[12:15], s28 offen nt
    s_xor_b32 s28, s26, 0x125c00
    v_and_b32_dpp v34, v55, v4 quad_perm:[3,3,3,3] row_mask:0xf bank_mask:0xf
    v_and_b32_dpp v35, v55, v5 quad_perm:[3,3,3,3] row_mask:0xf bank_mask:0xf
    s_nop 1
    v_mfma_f32_16x16x16_bf16 v[36:39], v[34:35], v[136:137], v[36:39]
    v_mfma_f32_16x16x16_bf16 v[40:43], v[34:35], v[138:139], v[40:43]
    s_waitcnt vmcnt(5)
    s_cbranch_vccnz L_w192
    s_waitcnt vmcnt(4)
L_w192:
    buffer_load_dwordx4 v[164:167], v2, s[12:15], s28 offen nt
    s_xor_b32 s28, s26, 0x1a5800
    v_and_b32_dpp v32, v56, v4 quad_perm:[0,0,0,0] row_mask:0xf bank_mask:0xf
    v_and_b32_dpp v33, v56, v5 quad_perm:[0,0,0,0] row_mask:0xf bank_mask:0xf
    s_nop 1
    v_mfma_f32_16x16x16_bf16 v[36:39], v[32:33], v[140:141], v[36:39]
    v_mfma_f32_16x16x16_bf16 v[40:43], v[32:33], v[142:143], v[40:43]
    s_waitcnt lgkmcnt(0)
    v_cmp_lt_i32 vcc, 0, v78
    v_mov_b32 v79, 96
    ds_write_b32 v76, v79 offset:16384
    ds_read_b32 v78, v77 offset:256
    s_waitcnt vmcnt(5)
    s_cbranch_vccnz L_w193
    s_waitcnt vmcnt(4)
L_w193:
    buffer_load_dwordx4 v[168:171], v2, s[12:15], s28 offen nt
    s_xor_b32 s28, s26, 0x131400
    v_and_b32_dpp v34, v56, v4 quad_perm:[1,1,1,1] row_mask:0xf bank_mask:0xf
    v_and_b32_dpp v35, v56, v5 quad_perm:[1,1,1,1] row_mask:0xf bank_mask:0xf
    s_nop 1
    v_mfma_f32_16x16x16_bf16 v[36:39], v[34:35], v[144:145], v[36:39]
    v_mfma_f32_16x16x16_bf16 v[40:43], v[34:35], v[146:147], v[40:43]
    s_waitcnt vmcnt(5)
    s_cbranch_vccnz L_w194
    s_waitcnt vmcnt(4)
L_w194:
    buffer_load_dwordx4 v[172:175], v2, s[12:15], s28 offen nt
    s_xor_b32 s28, s26, 0x1b1000
    v_and_b32_dpp v32, v56, v4 quad_perm:[2,2,2,2] row_mask:0xf bank_mask:0xf
    v_and_b32_dpp v33, v56, v5 quad_perm:[2,2,2,2] row_mask:0xf bank_mask:0xf
    s_nop 1
    v_mfma_f32_16x16x16_bf16 v[36:39], v[32:33], v[148:149], v[36:39]
    v_mfma_f32_16x16x16_bf16 v[40:43], v[32:33], v[150:151], v[40:43]
L_pad25:
    s_cmp_eq_u32 s51, 1
    s_cbranch_scc1 L_pad26
    s_waitcnt lgkmcnt(0)
    v_cmp_lt_i32 vcc, 2, v78
    v_mov_b32 v79, 97
    ds_write_b32 v76, v79 offset:16384
    ds_read_b32 v78, v77 offset:256
    s_waitcnt vmcnt(5)
    s_cbranch_vccnz L_w195
    s_waitcnt vmcnt(4)
L_w195:
    buffer_load_dwordx4 v[176:179], v2, s[12:15], s28 offen nt
    s_xor_b32 s28, s26, 0x131c00
    v_and_b32_dpp v34, v56, v4 quad_perm:[3,3,3,3] row_mask:0xf bank_mask:0xf
    v_and_b32_dpp v35, v56, v5 quad_perm:[3,3,3,3] row_mask:0xf bank_mask:0xf
    s_nop 1
    v_mfma_f32_16x16x16_bf16 v[36:39], v[34:35], v[152:153], v[36:39]
    v_mfma_f32_16x16x16_bf16 v[40:43], v[34:35], v[154:155], v[40:43]
    s_waitcnt vmcnt(5)
    s_cbranch_vccnz L_w196
    s_waitcnt vmcnt(4)
L_w196:
    buffer_load_dwordx4 v[180:183], v2, s[12:15], s28 offen nt
    s_xor_b32 s28, s26, 0x1b1800
    v_and_b32_dpp v32, v57, v4 quad_perm:[0,0,0,0] row_mask:0xf bank_mask:0xf
    v_and_b32_dpp v33, v57, v5 quad_perm:[0,0,0,0] row_mask:0xf bank_mask:0xf
    s_nop 1
    v_mfma_f32_16x16x16_bf16 v[36:39], v[32:33], v[156:157], v[36:39]
    v_mfma_f32_16x16x16_bf16 v[40:43], v[32:33], v[158:159], v[40:43]
    s_waitcnt lgkmcnt(0)
    v_cmp_lt_i32 vcc, 1, v78
    v_mov_b32 v79, 98
    ds_write_b32 v76, v79 offset:16384
    ds_read_b32 v78, v77 offset:256
    s_waitcnt vmcnt(5)
    s_cbranch_vccnz L_w197
    s_waitcnt vmcnt(4)
L_w197:
    buffer_load_dwordx4 v[184:187], v2, s[12:15], s28 offen nt
    s_xor_b32 s28, s26, 0x135400
    v_and_b32_dpp v34, v57, v4 quad_perm:[1,1,1,1] row_mask:0xf bank_mask:0xf
    v_and_b32_dpp v35, v57, v5 quad_perm:[1,1,1,1] row_mask:0xf bank_mask:0xf
    s_nop 1
    v_mfma_f32_16x16x16_bf16 v[36:39], v[34:35], v[160:161], v[36:39]
    v_mfma_f32_16x16x16_bf16 v[40:43], v[34:35], v[162:163], v[40:43]
    s_waitcnt vmcnt(5)
    s_cbranch_vccnz L_w198
    s_waitcnt vmcnt(4)
L_w198:
    buffer_load_dwordx4 v[188:191], v2, s[12:15], s28 offen nt
    s_xor_b32 s28, s26, 0x1b5000
    v_and_b32_dpp v32, v57, v4 quad_perm:[2,2,2,2] row_mask:0xf bank_mask:0xf
    v_and_b32_dpp v33, v57, v5 quad_perm:[2,2,2,2] row_mask:0xf bank_mask:0xf
    s_nop 1
    v_mfma_f32_16x16x16_bf16 v[36:39], v[32:33], v[164:165], v[36:39]
    v_mfma_f32_16x16x16_bf16 v[40:43], v[32:33], v[166:167], v[40:43]
    s_waitcnt lgkmcnt(0)
    v_cmp_lt_i32 vcc, 3, v78
    v_mov_b32 v79, 99
    ds_write_b32 v76, v79 offset:16384
    ds_read_b32 v78, v77 offset:256
    s_waitcnt vmcnt(5)
    s_cbranch_vccnz L_w199
    s_waitcnt vmcnt(4)
L_w199:
    buffer_load_dwordx4 v[192:195], v2, s[12:15], s28 offen nt
    s_xor_b32 s28, s26, 0x135c00
    v_and_b32_dpp v34, v57, v4 quad_perm:[3,3,3,3] row_mask:0xf bank_mask:0xf
    v_and_b32_dpp v35, v57, v5 quad_perm:[3,3,3,3] row_mask:0xf bank_mask:0xf
    s_nop 1
    v_mfma_f32_16x16x16_bf16 v[36:39], v[34:35], v[168:169], v[36:39]
    v_mfma_f32_16x16x16_bf16 v[40:43], v[34:35], v[170:171], v[40:43]
    s_waitcnt vmcnt(5)
    s_cbranch_vccnz L_w200
    s_waitcnt vmcnt(4)
L_w200:
    buffer_load_dwordx4 v[196:199], v2, s[12:15], s28 offen nt
    s_xor_b32 s28, s26, 0x1b5800
    v_and_b32_dpp v32, v58, v4 quad_perm:[0,0,0,0] row_mask:0xf bank_mask:0xf
    v_and_b32_dpp v33, v58, v5 quad_perm:[0,0,0,0] row_mask:0xf bank_mask:0xf
    s_nop 1
    v_mfma_f32_16x16x16_bf16 v[36:39], v[32:33], v[172:173], v[36:39]
    v_mfma_f32_16x16x16_bf16 v[40:43], v[32:33], v[174:175], v[40:43]
    s_waitcnt lgkmcnt(0)
    v_cmp_lt_i32 vcc, 0, v78
    v_mov_b32 v79, 100
    ds_write_b32 v76, v79 offset:16384
    ds_read_b32 v78, v77 offset:256
    s_waitcnt vmcnt(5)
    s_cbranch_vccnz L_w201
    s_waitcnt vmcnt(4)
L_w201:
    buffer_load_dwordx4 v[200:203], v2, s[12:15], s28 offen nt
    s_xor_b32 s28, s26, 0x408000
    v_and_b32_dpp v34, v58, v4 quad_perm:[1,1,1,1] row_mask:0xf bank_mask:0xf
    v_and_b32_dpp v35, v58, v5 quad_perm:[1,1,1,1] row_mask:0xf bank_mask:0xf
    s_nop 1
    v_mfma_f32_16x16x16_bf16 v[36:39], v[34:35], v[176:177], v[36:39]
    v_mfma_f32_16x16x16_bf16 v[40:43], v[34:35], v[178:179], v[40:43]
    s_waitcnt vmcnt(5)
    s_cbranch_vccnz L_w202
    s_waitcnt vmcnt(4)
L_w202:
    buffer_load_dwordx4 v[204:207], v2, s[12:15], s28 offen nt
    s_xor_b32 s28, s26, 0x488400
    v_and_b32_dpp v32, v58, v4 quad_perm:[2,2,2,2] row_mask:0xf bank_mask:0xf
    v_and_b32_dpp v33, v58, v5 quad_perm:[2,2,2,2] row_mask:0xf bank_mask:0xf
    s_nop 1
    v_mfma_f32_16x16x16_bf16 v[36:39], v[32:33], v[180:181], v[36:39]
    v_mfma_f32_16x16x16_bf16 v[40:43], v[32:33], v[182:183], v[40:43]
    s_waitcnt lgkmcnt(0)
    v_cmp_lt_i32 vcc, 2, v78
    v_mov_b32 v79, 101
    ds_write_b32 v76, v79 offset:16384
    ds_read_b32 v78, v77 offset:256
    s_waitcnt vmcnt(5)
    s_cbranch_vccnz L_w203
    s_waitcnt vmcnt(4)
L_w203:
    buffer_load_dwordx4 v[208:211], v2, s[12:15], s28 offen nt
    s_xor_b32 s28, s26, 0x408800
    v_and_b32_dpp v34, v58, v4 quad_perm:[3,3,3,3] row_mask:0xf bank_mask:0xf
    v_and_b32_dpp v35, v58, v5 quad_perm:[3,3,3,3] row_mask:0xf bank_mask:0xf
    s_nop 1
    v_mfma_f32_16x16x16_bf16 v[36:39], v[34:35], v[184:185], v[36:39]
    v_mfma_f32_16x16x16_bf16 v[40:43], v[34:35], v[186:187], v[40:43]
    s_waitcnt vmcnt(5)
    s_cbranch_vccnz L_w204
    s_waitcnt vmcnt(4)
L_w204:
    buffer_load_dwordx4 v[212:215], v2, s[12:15], s28 offen nt
    s_xor_b32 s28, s26, 0x488c00
    v_and_b32_dpp v32, v59, v4 quad_perm:[0,0,0,0] row_mask:0xf bank_mask:0xf
    v_and_b32_dpp v33, v59, v5 quad_perm:[0,0,0,0] row_mask:0xf bank_mask:0xf
    s_nop 1
    v_mfma_f32_16x16x16_bf16 v[36:39], v[32:33], v[188:189], v[36:39]
    v_mfma_f32_16x16x16_bf16 v[40:43], v[32:33], v[190:191], v[40:43]
    s_waitcnt lgkmcnt(0)
    v_cmp_lt_i32 vcc, 1, v78
    v_mov_b32 v79, 102
    ds_write_b32 v76, v79 offset:16384
    ds_read_b32 v78, v77 offset:256
    s_waitcnt vmcnt(5)
    s_cbranch_vccnz L_w205
    s_waitcnt vmcnt(4)
L_w205:
    buffer_load_dwordx4 v[80:83], v2, s[12:15], s28 offen nt
    s_xor_b32 s28, s26, 0x40c000
    v_and_b32_dpp v34, v59, v4 quad_perm:[1,1,1,1] row_mask:0xf bank_mask:0xf
    v_and_b32_dpp v35, v59, v5 quad_perm:[1,1,1,1] row_mask:0xf bank_mask:0xf
    s_nop 1
    v_mfma_f32_16x16x16_bf16 v[36:39], v[34:35], v[192:193], v[36:39]
    v_mfma_f32_16x16x16_bf16 v[40:43], v[34:35], v[194:195], v[40:43]
    s_waitcnt vmcnt(5)
    s_cbranch_vccnz L_w206
    s_waitcnt vmcnt(4)
L_w206:
    buffer_load_dwordx4 v[84:87], v2, s[12:15], s28 offen nt
    s_xor_b32 s28, s26, 0x48c400
    v_and_b32_dpp v32, v59, v4 quad_perm:[2,2,2,2] row_mask:0xf bank_mask:0xf
    v_and_b32_dpp v33, v59, v5 quad_perm:[2,2,2,2] row_mask:0xf bank_mask:0xf
    s_nop 1
    v_mfma_f32_16x16x16_bf16 v[36:39], v[32:33], v[196:197], v[36:39]
    v_mfma_f32_16x16x16_bf16 v[40:43], v[32:33], v[198:199], v[40:43]
    s_waitcnt lgkmcnt(0)
    v_cmp_lt_i32 vcc, 3, v78
    v_mov_b32 v79, 103
    ds_write_b32 v76, v79 offset:16384
    ds_read_b32 v78, v77 offset:256
L_pad26:
    s_cmp_eq_u32 s51, 1
    s_cbranch_scc1 L_pad27
    s_waitcnt vmcnt(5)
    s_cbranch_vccnz L_w207
    s_waitcnt vmcnt(4)
L_w207:
    buffer_load_dwordx4 v[88:91], v2, s[12:15], s28 offen nt
    s_xor_b32 s28, s26, 0x40c800
    v_and_b32_dpp v34, v59, v4 quad_perm:[3,3,3,3] row_mask:0xf bank_mask:0xf
    v_and_b32_dpp v35, v59, v5 quad_perm:[3,3,3,3] row_mask:0xf bank_mask:0xf
    s_nop 1
    v_mfma_f32_16x16x16_bf16 v[36:39], v[34:35], v[200:201], v[36:39]
    v_mfma_f32_16x16x16_bf16 v[40:43], v[34:35], v[202:203], v[40:43]
    s_waitcnt vmcnt(5)
    s_cbranch_vccnz L_w208
    s_waitcnt vmcnt(4)
L_w208:
    buffer_load_dwordx4 v[92:95], v2, s[12:15], s28 offen nt
    s_xor_b32 s28, s26, 0x48cc00
    v_and_b32_dpp v32, v60, v4 quad_perm:[0,0,0,0] row_mask:0xf bank_mask:0xf
    v_and_b32_dpp v33, v60, v5 quad_perm:[0,0,0,0] row_mask:0xf bank_mask:0xf
    s_nop 1
    v_mfma_f32_16x16x16_bf16 v[36:39], v[32:33], v[204:205], v[36:39]
    v_mfma_f32_16x16x16_bf16 v[40:43], v[32:33], v[206:207], v[40:43]
    s_waitcnt lgkmcnt(0)
    v_cmp_lt_i32 vcc, 0, v78
    v_mov_b32 v79, 104
    ds_write_b32 v76, v79 offset:16384
    ds_read_b32 v78, v77 offset:256
    s_waitcnt vmcnt(5)
    s_cbranch_vccnz L_w209
    s_waitcnt vmcnt(4)
L_w209:
    buffer_load_dwordx4 v[96:99], v2, s[12:15], s28 offen nt
    s_xor_b32 s28, s26, 0x418000
    v_and_b32_dpp v34, v60, v4 quad_perm:[1,1,1,1] row_mask:0xf bank_mask:0xf
    v_and_b32_dpp v35, v60, v5 quad_perm:[1,1,1,1] row_mask:0xf bank_mask:0xf
    s_nop 1
    v_mfma_f32_16x16x16_bf16 v[36:39], v[34:35], v[208:209], v[36:39]
    v_mfma_f32_16x16x16_bf16 v[40:43], v[34:35], v[210:211], v[40:43]
    s_waitcnt vmcnt(5)
    s_cbranch_vccnz L_w210
    s_waitcnt vmcnt(4)
L_w210:
    buffer_load_dwordx4 v[100:103], v2, s[12:15], s28 offen nt
    s_xor_b32 s28, s26, 0x498400
    v_and_b32_dpp v32, v60, v4 quad_perm:[2,2,2,2] row_mask:0xf bank_mask:0xf
    v_and_b32_dpp v33, v60, v5 quad_perm:[2,2,2,2] row_mask:0xf bank_mask:0xf
    s_nop 1
    v_mfma_f32_16x16x16_bf16 v[36:39], v[32:33], v[212:213], v[36:39]
    v_mfma_f32_16x16x16_bf16 v[40:43], v[32:33], v[214:215], v[40:43]
    s_waitcnt lgkmcnt(0)
    v_cmp_lt_i32 vcc, 2, v78
    v_mov_b32 v79, 105
    ds_write_b32 v76, v79 offset:16384
    ds_read_b32 v78, v77 offset:256
    s_waitcnt vmcnt(5)
    s_cbranch_vccnz L_w211
    s_waitcnt vmcnt(4)
L_w211:
    buffer_load_dwordx4 v[104:107], v2, s[12:15], s28 offen nt
    s_xor_b32 s28, s26, 0x418800
    v_and_b32_dpp v34, v60, v4 quad_perm:[3,3,3,3] row_mask:0xf bank_mask:0xf
    v_and_b32_dpp v35, v60, v5 quad_perm:[3,3,3,3] row_mask:0xf bank_mask:0xf
    s_nop 1
    v_mfma_f32_16x16x16_bf16 v[36:39], v[34:35], v[80:81], v[36:39]
    v_mfma_f32_16x16x16_bf16 v[40:43], v[34:35], v[82:83], v[40:43]
    s_waitcnt vmcnt(5)
    s_cbranch_vccnz L_w212
    s_waitcnt vmcnt(4)
L_w212:
    buffer_load_dwordx4 v[108:111], v2, s[12:15], s28 offen nt
    s_xor_b32 s28, s26, 0x498c00
    v_and_b32_dpp v32, v61, v4 quad_perm:[0,0,0,0] row_mask:0xf bank_mask:0xf
    v_and_b32_dpp v33, v61, v5 quad_perm:[0,0,0,0] row_mask:0xf bank_mask:0xf
    s_nop 1
    v_mfma_f32_16x16x16_bf16 v[36:39], v[32:33], v[84:85], v[36:39]
    v_mfma_f32_16x16x16_bf16 v[40:43], v[32:33], v[86:87], v[40:43]
    s_waitcnt lgkmcnt(0)
    v_cmp_lt_i32 vcc, 1, v78
    v_mov_b32 v79, 106
    ds_write_b32 v76, v79 offset:16384
    ds_read_b32 v78, v77 offset:256
    s_waitcnt vmcnt(5)
    s_cbranch_vccnz L_w213
    s_waitcnt vmcnt(4)
L_w213:
    buffer_load_dwordx4 v[112:115], v2, s[12:15], s28 offen nt
    s_xor_b32 s28, s26, 0x41c000
    v_and_b32_dpp v34, v61, v4 quad_perm:[1,1,1,1] row_mask:0xf bank_mask:0xf
    v_and_b32_dpp v35, v61, v5 quad_perm:[1,1,1,1] row_mask:0xf bank_mask:0xf
    s_nop 1
    v_mfma_f32_16x16x16_bf16 v[36:39], v[34:35], v[88:89], v[36:39]
    v_mfma_f32_16x16x16_bf16 v[40:43], v[34:35], v[90:91], v[40:43]
    s_waitcnt vmcnt(5)
    s_cbranch_vccnz L_w214
    s_waitcnt vmcnt(4)
L_w214:
    buffer_load_dwordx4 v[116:119], v2, s[12:15], s28 offen nt
    s_xor_b32 s28, s26, 0x49c400
    v_and_b32_dpp v32, v61, v4 quad_perm:[2,2,2,2] row_mask:0xf bank_mask:0xf
    v_and_b32_dpp v33, v61, v5 quad_perm:[2,2,2,2] row_mask:0xf bank_mask:0xf
    s_nop 1
    v_mfma_f32_16x16x16_bf16 v[36:39], v[32:33], v[92:93], v[36:39]
    v_mfma_f32_16x16x16_bf16 v[40:43], v[32:33], v[94:95], v[40:43]
    s_waitcnt lgkmcnt(0)
    v_cmp_lt_i32 vcc, 3, v78
    v_mov_b32 v79, 107
    ds_write_b32 v76, v79 offset:16384
    ds_read_b32 v78, v77 offset:256
    s_waitcnt vmcnt(5)
    s_cbranch_vccnz L_w215
    s_waitcnt vmcnt(4)
L_w215:
    buffer_load_dwordx4 v[120:123], v2, s[12:15], s28 offen nt
    s_xor_b32 s28, s26, 0x41c800
    v_and_b32_dpp v34, v61, v4 quad_perm:[3,3,3,3] row_mask:0xf bank_mask:0xf
    v_and_b32_dpp v35, v61, v5 quad_perm:[3,3,3,3] row_mask:0xf bank_mask:0xf
    s_nop 1
    v_mfma_f32_16x16x16_bf16 v[36:39], v[34:35], v[96:97], v[36:39]
    v_mfma_f32_16x16x16_bf16 v[40:43], v[34:35], v[98:99], v[40:43]
    s_waitcnt vmcnt(5)
    s_cbranch_vccnz L_w216
    s_waitcnt vmcnt(4)
L_w216:
    buffer_load_dwordx4 v[124:127], v2, s[12:15], s28 offen nt
    s_xor_b32 s28, s26, 0x49cc00
    v_and_b32_dpp v32, v62, v4 quad_perm:[0,0,0,0] row_mask:0xf bank_mask:0xf
    v_and_b32_dpp v33, v62, v5 quad_perm:[0,0,0,0] row_mask:0xf bank_mask:0xf
    s_nop 1
    v_mfma_f32_16x16x16_bf16 v[36:39], v[32:33], v[100:101], v[36:39]
    v_mfma_f32_16x16x16_bf16 v[40:43], v[32:33], v[102:103], v[40:43]
    s_waitcnt lgkmcnt(0)
    v_cmp_lt_i32 vcc, 0, v78
    v_mov_b32 v79, 108
    ds_write_b32 v76, v79 offset:16384
    ds_read_b32 v78, v77 offset:256
    s_waitcnt vmcnt(5)
    s_cbranch_vccnz L_w217
    s_waitcnt vmcnt(4)
L_w217:
    buffer_load_dwordx4 v[128:131], v2, s[12:15], s28 offen nt
    s_xor_b32 s28, s26, 0x428400
    v_and_b32_dpp v34, v62, v4 quad_perm:[1,1,1,1] row_mask:0xf bank_mask:0xf
    v_and_b32_dpp v35, v62, v5 quad_perm:[1,1,1,1] row_mask:0xf bank_mask:0xf
    s_nop 1
    v_mfma_f32_16x16x16_bf16 v[36:39], v[34:35], v[104:105], v[36:39]
    v_mfma_f32_16x16x16_bf16 v[40:43], v[34:35], v[106:107], v[40:43]
    s_waitcnt vmcnt(5)
    s_cbranch_vccnz L_w218
    s_waitcnt vmcnt(4)
L_w218:
    buffer_load_dwordx4 v[132:135], v2, s[12:15], s28 offen nt
    s_xor_b32 s28, s26, 0x4a8000
    v_and_b32_dpp v32, v62, v4 quad_perm:[2,2,2,2] row_mask:0xf bank_mask:0xf
    v_and_b32_dpp v33, v62, v5 quad_perm:[2,2,2,2] row_mask:0xf bank_mask:0xf
    s_nop 1
    v_mfma_f32_16x16x16_bf16 v[36:39], v[32:33], v[108:109], v[36:39]
    v_mfma_f32_16x16x16_bf16 v[40:43], v[32:33], v[110:111], v[40:43]
    s_waitcnt lgkmcnt(0)
    v_cmp_lt_i32 vcc, 2, v78
    v_mov_b32 v79, 109
    ds_write_b32 v76, v79 offset:16384
    ds_read_b32 v78, v77 offset:256
    s_waitcnt vmcnt(5)
    s_cbranch_vccnz L_w219
    s_waitcnt vmcnt(4)
L_w219:
    buffer_load_dwordx4 v[136:139], v2, s[12:15], s28 offen nt
    s_xor_b32 s28, s26, 0x428c00
    v_and_b32_dpp v34, v62, v4 quad_perm:[3,3,3,3] row_mask:0xf bank_mask:0xf
    v_and_b32_dpp v35, v62, v5 quad_perm:[3,3,3,3] row_mask:0xf bank_mask:0xf
    s_nop 1
    v_mfma_f32_16x16x16_bf16 v[36:39], v[34:35], v[112:113], v[36:39]
    v_mfma_f32_16x16x16_bf16 v[40:43], v[34:35], v[114:115], v[40:43]
L_pad27:
    s_cmp_eq_u32 s51, 1
    s_cbranch_scc1 L_pad28
    s_waitcnt vmcnt(5)
    s_cbranch_vccnz L_w220
    s_waitcnt vmcnt(4)
L_w220:
    buffer_load_dwordx4 v[140:143], v2, s[12:15], s28 offen nt
    s_xor_b32 s28, s26, 0x4a8800
    v_and_b32_dpp v32, v63, v4 quad_perm:[0,0,0,0] row_mask:0xf bank_mask:0xf
    v_and_b32_dpp v33, v63, v5 quad_perm:[0,0,0,0] row_mask:0xf bank_mask:0xf
    s_nop 1
    v_mfma_f32_16x16x16_bf16 v[36:39], v[32:33], v[116:117], v[36:39]
    v_mfma_f32_16x16x16_bf16 v[40:43], v[32:33], v[118:119], v[40:43]
    s_waitcnt lgkmcnt(0)
    v_cmp_lt_i32 vcc, 1, v78
    v_mov_b32 v79, 110
    ds_write_b32 v76, v79 offset:16384
    ds_read_b32 v78, v77 offset:256
    s_waitcnt vmcnt(5)
    s_cbranch_vccnz L_w221
    s_waitcnt vmcnt(4)
L_w221:
    buffer_load_dwordx4 v[144:147], v2, s[12:15], s28 offen nt
    s_xor_b32 s28, s26, 0x42c400
    v_and_b32_dpp v34, v63, v4 quad_perm:[1,1,1,1] row_mask:0xf bank_mask:0xf
    v_and_b32_dpp v35, v63, v5 quad_perm:[1,1,1,1] row_mask:0xf bank_mask:0xf
    s_nop 1
    v_mfma_f32_16x16x16_bf16 v[36:39], v[34:35], v[120:121], v[36:39]
    v_mfma_f32_16x16x16_bf16 v[40:43], v[34:35], v[122:123], v[40:43]
    s_waitcnt vmcnt(5)
    s_cbranch_vccnz L_w222
    s_waitcnt vmcnt(4)
L_w222:
    buffer_load_dwordx4 v[148:151], v2, s[12:15], s28 offen nt
    s_xor_b32 s28, s26, 0x4ac000
    v_and_b32_dpp v32, v63, v4 quad_perm:[2,2,2,2] row_mask:0xf bank_mask:0xf
    v_and_b32_dpp v33, v63, v5 quad_perm:[2,2,2,2] row_mask:0xf bank_mask:0xf
    s_nop 1
    v_mfma_f32_16x16x16_bf16 v[36:39], v[32:33], v[124:125], v[36:39]
    v_mfma_f32_16x16x16_bf16 v[40:43], v[32:33], v[126:127], v[40:43]
    s_waitcnt lgkmcnt(0)
    v_cmp_lt_i32 vcc, 3, v78
    v_mov_b32 v79, 111
    ds_write_b32 v76, v79 offset:16384
    ds_read_b32 v78, v77 offset:256
    s_waitcnt vmcnt(5)
    s_cbranch_vccnz L_w223
    s_waitcnt vmcnt(4)
L_w223:
    buffer_load_dwordx4 v[152:155], v2, s[12:15], s28 offen nt
    s_xor_b32 s28, s26, 0x42cc00
    v_and_b32_dpp v34, v63, v4 quad_perm:[3,3,3,3] row_mask:0xf bank_mask:0xf
    v_and_b32_dpp v35, v63, v5 quad_perm:[3,3,3,3] row_mask:0xf bank_mask:0xf
    s_nop 1
    v_mfma_f32_16x16x16_bf16 v[36:39], v[34:35], v[128:129], v[36:39]
    v_mfma_f32_16x16x16_bf16 v[40:43], v[34:35], v[130:131], v[40:43]
    s_waitcnt vmcnt(5)
    s_cbranch_vccnz L_w224
    s_waitcnt vmcnt(4)
L_w224:
    buffer_load_dwordx4 v[156:159], v2, s[12:15], s28 offen nt
    s_xor_b32 s28, s26, 0x4ac800
    v_and_b32_dpp v32, v64, v4 quad_perm:[0,0,0,0] row_mask:0xf bank_mask:0xf
    v_and_b32_dpp v33, v64, v5 quad_perm:[0,0,0,0] row_mask:0xf bank_mask:0xf
    s_nop 1
    v_mfma_f32_16x16x16_bf16 v[36:39], v[32:33], v[132:133], v[36:39]
    v_mfma_f32_16x16x16_bf16 v[40:43], v[32:33], v[134:135], v[40:43]
    s_waitcnt lgkmcnt(0)
    v_cmp_lt_i32 vcc, 0, v78
    v_mov_b32 v79, 112
    ds_write_b32 v76, v79 offset:16384
    ds_read_b32 v78, v77 offset:256
    s_waitcnt vmcnt(5)
    s_cbranch_vccnz L_w225
    s_waitcnt vmcnt(4)
L_w225:
    buffer_load_dwordx4 v[160:163], v2, s[12:15], s28 offen nt
    s_xor_b32 s28, s26, 0x438400
    v_and_b32_dpp v34, v64, v4 quad_perm:[1,1,1,1] row_mask:0xf bank_mask:0xf
    v_and_b32_dpp v35, v64, v5 quad_perm:[1,1,1,1] row_mask:0xf bank_mask:0xf
    s_nop 1
    v_mfma_f32_16x16x16_bf16 v[36:39], v[34:35], v[136:137], v[36:39]
    v_mfma_f32_16x16x16_bf16 v[40:43], v[34:35], v[138:139], v[40:43]
    s_waitcnt vmcnt(5)
    s_cbranch_vccnz L_w226
    s_waitcnt vmcnt(4)
L_w226:
    buffer_load_dwordx4 v[164:167], v2, s[12:15], s28 offen nt
    s_xor_b32 s28, s26, 0x4b8000
    v_and_b32_dpp v32, v64, v4 quad_perm:[2,2,2,2] row_mask:0xf bank_mask:0xf
    v_and_b32_dpp v33, v64, v5 quad_perm:[2,2,2,2] row_mask:0xf bank_mask:0xf
    s_nop 1
    v_mfma_f32_16x16x16_bf16 v[36:39], v[32:33], v[140:141], v[36:39]
    v_mfma_f32_16x16x16_bf16 v[40:43], v[32:33], v[142:143], v[40:43]
    s_waitcnt lgkmcnt(0)
    v_cmp_lt_i32 vcc, 2, v78
    v_mov_b32 v79, 113
    ds_write_b32 v76, v79 offset:16384
    ds_read_b32 v78, v77 offset:256
    s_waitcnt vmcnt(5)
    s_cbranch_vccnz L_w227
    s_waitcnt vmcnt(4)
L_w227:
    buffer_load_dwordx4 v[168:171], v2, s[12:15], s28 offen nt
    s_xor_b32 s28, s26, 0x438c00
    v_and_b32_dpp v34, v64, v4 quad_perm:[3,3,3,3] row_mask:0xf bank_mask:0xf
    v_and_b32_dpp v35, v64, v5 quad_perm:[3,3,3,3] row_mask:0xf bank_mask:0xf
    s_nop 1
    v_mfma_f32_16x16x16_bf16 v[36:39], v[34:35], v[144:145], v[36:39]
    v_mfma_f32_16x16x16_bf16 v[40:43], v[34:35], v[146:147], v[40:43]
    s_waitcnt vmcnt(5)
    s_cbranch_vccnz L_w228
    s_waitcnt vmcnt(4)
L_w228:
    buffer_load_dwordx4 v[172:175], v2, s[12:15], s28 offen nt
    s_xor_b32 s28, s26, 0x4b8800
    v_and_b32_dpp v32, v65, v4 quad_perm:[0,0,0,0] row_mask:0xf bank_mask:0xf
    v_and_b32_dpp v33, v65, v5 quad_perm:[0,0,0,0] row_mask:0xf bank_mask:0xf
    s_nop 1
    v_mfma_f32_16x16x16_bf16 v[36:39], v[32:33], v[148:149], v[36:39]
    v_mfma_f32_16x16x16_bf16 v[40:43], v[32:33], v[150:151], v[40:43]
    s_waitcnt lgkmcnt(0)
    v_cmp_lt_i32 vcc, 1, v78
    v_mov_b32 v79, 114
    ds_write_b32 v76, v79 offset:16384
    ds_read_b32 v78, v77 offset:256
    s_waitcnt vmcnt(5)
    s_cbranch_vccnz L_w229
    s_waitcnt vmcnt(4)
L_w229:
    buffer_load_dwordx4 v[176:179], v2, s[12:15], s28 offen nt
    s_xor_b32 s28, s26, 0x43c400
    v_and_b32_dpp v34, v65, v4 quad_perm:[1,1,1,1] row_mask:0xf bank_mask:0xf
    v_and_b32_dpp v35, v65, v5 quad_perm:[1,1,1,1] row_mask:0xf bank_mask:0xf
    s_nop 1
    v_mfma_f32_16x16x16_bf16 v[36:39], v[34:35], v[152:153], v[36:39]
    v_mfma_f32_16x16x16_bf16 v[40:43], v[34:35], v[154:155], v[40:43]
    s_waitcnt vmcnt(5)
    s_cbranch_vccnz L_w230
    s_waitcnt vmcnt(4)
L_w230:
    buffer_load_dwordx4 v[180:183], v2, s[12:15], s28 offen nt
    s_xor_b32 s28, s26, 0x4bc000
    v_and_b32_dpp v32, v65, v4 quad_perm:[2,2,2,2] row_mask:0xf bank_mask:0xf
    v_and_b32_dpp v33, v65, v5 quad_perm:[2,2,2,2] row_mask:0xf bank_mask:0xf
    s_nop 1
    v_mfma_f32_16x16x16_bf16 v[36:39], v[32:33], v[156:157], v[36:39]
    v_mfma_f32_16x16x16_bf16 v[40:43], v[32:33], v[158:159], v[40:43]
    s_waitcnt lgkmcnt(0)
    v_cmp_lt_i32 vcc, 3, v78
    v_mov_b32 v79, 115
    ds_write_b32 v76, v79 offset:16384
    ds_read_b32 v78, v77 offset:256
    s_waitcnt vmcnt(5)
    s_cbranch_vccnz L_w231
    s_waitcnt vmcnt(4)
L_w231:
    buffer_load_dwordx4 v[184:187], v2, s[12:15], s28 offen nt
    s_xor_b32 s28, s26, 0x43cc00
    v_and_b32_dpp v34, v65, v4 quad_perm:[3,3,3,3] row_mask:0xf bank_mask:0xf
    v_and_b32_dpp v35, v65, v5 quad_perm:[3,3,3,3] row_mask:0xf bank_mask:0xf
    s_nop 1
    v_mfma_f32_16x16x16_bf16 v[36:39], v[34:35], v[160:161], v[36:39]
    v_mfma_f32_16x16x16_bf16 v[40:43], v[34:35], v[162:163], v[40:43]
    s_waitcnt vmcnt(5)
    s_cbranch_vccnz L_w232
    s_waitcnt vmcnt(4)
L_w232:
    buffer_load_dwordx4 v[188:191], v2, s[12:15], s28 offen nt
    s_xor_b32 s28, s26, 0x4bc800
    v_and_b32_dpp v32, v66, v4 quad_perm:[0,0,0,0] row_mask:0xf bank_mask:0xf
    v_and_b32_dpp v33, v66, v5 quad_perm:[0,0,0,0] row_mask:0xf bank_mask:0xf
    s_nop 1
    v_mfma_f32_16x16x16_bf16 v[36:39], v[32:33], v[164:165], v[36:39]
    v_mfma_f32_16x16x16_bf16 v[40:43], v[32:33], v[166:167], v[40:43]
L_pad28:
    s_cmp_eq_u32 s51, 1
    s_cbranch_scc1 L_pad29
    s_waitcnt lgkmcnt(0)
    v_cmp_lt_i32 vcc, 0, v78
    v_mov_b32 v79, 116
    ds_write_b32 v76, v79 offset:16384
    ds_read_b32 v78, v77 offset:256
    s_waitcnt vmcnt(5)
    s_cbranch_vccnz L_w233
    s_waitcnt vmcnt(4)
L_w233:
    buffer_load_dwordx4 v[192:195], v2, s[12:15], s28 offen nt
    s_xor_b32 s28, s26, 0x509000
    v_and_b32_dpp v34, v66, v4 quad_perm:[1,1,1,1] row_mask:0xf bank_mask:0xf
    v_and_b32_dpp v35, v66, v5 quad_perm:[1,1,1,1] row_mask:0xf bank_mask:0xf
    s_nop 1
    v_mfma_f32_16x16x16_bf16 v[36:39], v[34:35], v[168:169], v[36:39]
    v_mfma_f32_16x16x16_bf16 v[40:43], v[34:35], v[170:171], v[40:43]
    s_waitcnt vmcnt(5)
    s_cbranch_vccnz L_w234
    s_waitcnt vmcnt(4)
L_w234:
    buffer_load_dwordx4 v[196:199], v2, s[12:15], s28 offen nt
    s_xor_b32 s28, s26, 0x589400
    v_and_b32_dpp v32, v66, v4 quad_perm:[2,2,2,2] row_mask:0xf bank_mask:0xf
    v_and_b32_dpp v33, v66, v5 quad_perm:[2,2,2,2] row_mask:0xf bank_mask:0xf
    s_nop 1
    v_mfma_f32_16x16x16_bf16 v[36:39], v[32:33], v[172:173], v[36:39]
    v_mfma_f32_16x16x16_bf16 v[40:43], v[32:33], v[174:175], v[40:43]
    s_waitcnt lgkmcnt(0)
    v_cmp_lt_i32 vcc, 2, v78
    v_mov_b32 v79, 117
    ds_write_b32 v76, v79 offset:16384
    ds_read_b32 v78, v77 offset:256
    s_waitcnt vmcnt(5)
    s_cbranch_vccnz L_w235
    s_waitcnt vmcnt(4)
L_w235:
    buffer_load_dwordx4 v[200:203], v2, s[12:15], s28 offen nt
    s_xor_b32 s28, s26, 0x509800
    v_and_b32_dpp v34, v66, v4 quad_perm:[3,3,3,3] row_mask:0xf bank_mask:0xf
    v_and_b32_dpp v35, v66, v5 quad_perm:[3,3,3,3] row_mask:0xf bank_mask:0xf
    s_nop 1
    v_mfma_f32_16x16x16_bf16 v[36:39], v[34:35], v[176:177], v[36:39]
    v_mfma_f32_16x16x16_bf16 v[40:43], v[34:35], v[178:179], v[40:43]
    s_waitcnt vmcnt(5)
    s_cbranch_vccnz L_w236
    s_waitcnt vmcnt(4)
L_w236:
    buffer_load_dwordx4 v[204:207], v2, s[12:15], s28 offen nt
    s_xor_b32 s28, s26, 0x589c00
    v_and_b32_dpp v32, v67, v4 quad_perm:[0,0,0,0] row_mask:0xf bank_mask:0xf
    v_and_b32_dpp v33, v67, v5 quad_perm:[0,0,0,0] row_mask:0xf bank_mask:0xf
    s_nop 1
    v_mfma_f32_16x16x16_bf16 v[36:39], v[32:33], v[180:181], v[36:39]
    v_mfma_f32_16x16x16_bf16 v[40:43], v[32:33], v[182:183], v[40:43]
    s_waitcnt lgkmcnt(0)
    v_cmp_lt_i32 vcc, 1, v78
    v_mov_b32 v79, 118
    ds_write_b32 v76, v79 offset:16384
    ds_read_b32 v78, v77 offset:256
    s_waitcnt vmcnt(5)
    s_cbranch_vccnz L_w237
    s_waitcnt vmcnt(4)
L_w237:
    buffer_load_dwordx4 v[208:211], v2, s[12:15], s28 offen nt
    s_xor_b32 s28, s26, 0x50d000
    v_and_b32_dpp v34, v67, v4 quad_perm:[1,1,1,1] row_mask:0xf bank_mask:0xf
    v_and_b32_dpp v35, v67, v5 quad_perm:[1,1,1,1] row_mask:0xf bank_mask:0xf
    s_nop 1
    v_mfma_f32_16x16x16_bf16 v[36:39], v[34:35], v[184:185], v[36:39]
    v_mfma_f32_16x16x16_bf16 v[40:43], v[34:35], v[186:187], v[40:43]
    s_waitcnt vmcnt(5)
    s_cbranch_vccnz L_w238
    s_waitcnt vmcnt(4)
L_w238:
    buffer_load_dwordx4 v[212:215], v2, s[12:15], s28 offen nt
    s_xor_b32 s28, s26, 0x58d400
    v_and_b32_dpp v32, v67, v4 quad_perm:[2,2,2,2] row_mask:0xf bank_mask:0xf
    v_and_b32_dpp v33, v67, v5 quad_perm:[2,2,2,2] row_mask:0xf bank_mask:0xf
    s_nop 1
    v_mfma_f32_16x16x16_bf16 v[36:39], v[32:33], v[188:189], v[36:39]
    v_mfma_f32_16x16x16_bf16 v[40:43], v[32:33], v[190:191], v[40:43]
    s_waitcnt lgkmcnt(0)
    v_cmp_lt_i32 vcc, 3, v78
    v_mov_b32 v79, 119
    ds_write_b32 v76, v79 offset:16384
    ds_read_b32 v78, v77 offset:256
    s_waitcnt vmcnt(5)
    s_cbranch_vccnz L_w239
    s_waitcnt vmcnt(4)
L_w239:
    buffer_load_dwordx4 v[80:83], v2, s[12:15], s28 offen nt
    s_xor_b32 s28, s26, 0x50d800
    v_and_b32_dpp v34, v67, v4 quad_perm:[3,3,3,3] row_mask:0xf bank_mask:0xf
    v_and_b32_dpp v35, v67, v5 quad_perm:[3,3,3,3] row_mask:0xf bank_mask:0xf
    s_nop 1
    v_mfma_f32_16x16x16_bf16 v[36:39], v[34:35], v[192:193], v[36:39]
    v_mfma_f32_16x16x16_bf16 v[40:43], v[34:35], v[194:195], v[40:43]
    s_waitcnt vmcnt(5)
    s_cbranch_vccnz L_w240
    s_waitcnt vmcnt(4)
L_w240:
    buffer_load_dwordx4 v[84:87], v2, s[12:15], s28 offen nt
    s_xor_b32 s28, s26, 0x58dc00
    v_and_b32_dpp v32, v68, v4 quad_perm:[0,0,0,0] row_mask:0xf bank_mask:0xf
    v_and_b32_dpp v33, v68, v5 quad_perm:[0,0,0,0] row_mask:0xf bank_mask:0xf
    s_nop 1
    v_mfma_f32_16x16x16_bf16 v[36:39], v[32:33], v[196:197], v[36:39]
    v_mfma_f32_16x16x16_bf16 v[40:43], v[32:33], v[198:199], v[40:43]
    s_waitcnt lgkmcnt(0)
    v_cmp_lt_i32 vcc, 0, v78
    v_mov_b32 v79, 120
    ds_write_b32 v76, v79 offset:16384
    ds_read_b32 v78, v77 offset:256
    s_waitcnt vmcnt(5)
    s_cbranch_vccnz L_w241
    s_waitcnt vmcnt(4)
L_w241:
    buffer_load_dwordx4 v[88:91], v2, s[12:15], s28 offen nt
    s_xor_b32 s28, s26, 0x519000
    v_and_b32_dpp v34, v68, v4 quad_perm:[1,1,1,1] row_mask:0xf bank_mask:0xf
    v_and_b32_dpp v35, v68, v5 quad_perm:[1,1,1,1] row_mask:0xf bank_mask:0xf
    s_nop 1
    v_mfma_f32_16x16x16_bf16 v[36:39], v[34:35], v[200:201], v[36:39]
    v_mfma_f32_16x16x16_bf16 v[40:43], v[34:35], v[202:203], v[40:43]
    s_waitcnt vmcnt(5)
    s_cbranch_vccnz L_w242
    s_waitcnt vmcnt(4)
L_w242:
    buffer_load_dwordx4 v[92:95], v2, s[12:15], s28 offen nt
    s_xor_b32 s28, s26, 0x599400
    v_and_b32_dpp v32, v68, v4 quad_perm:[2,2,2,2] row_mask:0xf bank_mask:0xf
    v_and_b32_dpp v33, v68, v5 quad_perm:[2,2,2,2] row_mask:0xf bank_mask:0xf
    s_nop 1
    v_mfma_f32_16x16x16_bf16 v[36:39], v[32:33], v[204:205], v[36:39]
    v_mfma_f32_16x16x16_bf16 v[40:43], v[32:33], v[206:207], v[40:43]
    s_waitcnt lgkmcnt(0)
    v_cmp_lt_i32 vcc, 2, v78
    v_mov_b32 v79, 121
    ds_write_b32 v76, v79 offset:16384
    ds_read_b32 v78, v77 offset:256
    s_waitcnt vmcnt(5)
    s_cbranch_vccnz L_w243
    s_waitcnt vmcnt(4)
L_w243:
    buffer_load_dwordx4 v[96:99], v2, s[12:15], s28 offen nt
    s_xor_b32 s28, s26, 0x519800
    v_and_b32_dpp v34, v68, v4 quad_perm:[3,3,3,3] row_mask:0xf bank_mask:0xf
    v_and_b32_dpp v35, v68, v5 quad_perm:[3,3,3,3] row_mask:0xf bank_mask:0xf
    s_nop 1
    v_mfma_f32_16x16x16_bf16 v[36:39], v[34:35], v[208:209], v[36:39]
    v_mfma_f32_16x16x16_bf16 v[40:43], v[34:35], v[210:211], v[40:43]
    s_waitcnt vmcnt(5)
    s_cbranch_vccnz L_w244
    s_waitcnt vmcnt(4)
L_w244:
    buffer_load_dwordx4 v[100:103], v2, s[12:15], s28 offen nt
    s_xor_b32 s28, s26, 0x599c00
    v_and_b32_dpp v32, v69, v4 quad_perm:[0,0,0,0] row_mask:0xf bank_mask:0xf
    v_and_b32_dpp v33, v69, v5 quad_perm:[0,0,0,0] row_mask:0xf bank_mask:0xf
    s_nop 1
    v_mfma_f32_16x16x16_bf16 v[36:39], v[32:33], v[212:213], v[36:39]
    v_mfma_f32_16x16x16_bf16 v[40:43], v[32:33], v[214:215], v[40:43]
    s_waitcnt lgkmcnt(0)
    v_cmp_lt_i32 vcc, 1, v78
    v_mov_b32 v79, 122
    ds_write_b32 v76, v79 offset:16384
    ds_read_b32 v78, v77 offset:256
    s_waitcnt vmcnt(5)
    s_cbranch_vccnz L_w245
    s_waitcnt vmcnt(4)
L_w245:
    buffer_load_dwordx4 v[104:107], v2, s[12:15], s28 offen nt
    s_xor_b32 s28, s26, 0x51d000
L_pad29:
    s_cmp_eq_u32 s51, 1
    s_cbranch_scc1 L_pad30
    v_and_b32_dpp v34, v69, v4 quad_perm:[1,1,1,1] row_mask:0xf bank_mask:0xf
    v_and_b32_dpp v35, v69, v5 quad_perm:[1,1,1,1] row_mask:0xf bank_mask:0xf
    s_nop 1
    v_mfma_f32_16x16x16_bf16 v[36:39], v[34:35], v[80:81], v[36:39]
    v_mfma_f32_16x16x16_bf16 v[40:43], v[34:35], v[82:83], v[40:43]
    s_waitcnt vmcnt(5)
    s_cbranch_vccnz L_w246
    s_waitcnt vmcnt(4)
L_w246:
    buffer_load_dwordx4 v[108:111], v2, s[12:15], s28 offen nt
    s_xor_b32 s28, s26, 0x59d400
    v_and_b32_dpp v32, v69, v4 quad_perm:[2,2,2,2] row_mask:0xf bank_mask:0xf
    v_and_b32_dpp v33, v69, v5 quad_perm:[2,2,2,2] row_mask:0xf bank_mask:0xf
    s_nop 1
    v_mfma_f32_16x16x16_bf16 v[36:39], v[32:33], v[84:85], v[36:39]
    v_mfma_f32_16x16x16_bf16 v[40:43], v[32:33], v[86:87], v[40:43]
    s_waitcnt lgkmcnt(0)
    v_cmp_lt_i32 vcc, 3, v78
    v_mov_b32 v79, 123
    ds_write_b32 v76, v79 offset:16384
    ds_read_b32 v78, v77 offset:256
    s_waitcnt vmcnt(5)
    s_cbranch_vccnz L_w247
    s_waitcnt vmcnt(4)
L_w247:
    buffer_load_dwordx4 v[112:115], v2, s[12:15], s28 offen nt
    s_xor_b32 s28, s26, 0x51d800
    v_and_b32_dpp v34, v69, v4 quad_perm:[3,3,3,3] row_mask:0xf bank_mask:0xf
    v_and_b32_dpp v35, v69, v5 quad_perm:[3,3,3,3] row_mask:0xf bank_mask:0xf
    s_nop 1
    v_mfma_f32_16x16x16_bf16 v[36:39], v[34:35], v[88:89], v[36:39]
    v_mfma_f32_16x16x16_bf16 v[40:43], v[34:35], v[90:91], v[40:43]
    s_waitcnt vmcnt(5)
    s_cbranch_vccnz L_w248
    s_waitcnt vmcnt(4)
L_w248:
    buffer_load_dwordx4 v[116:119], v2, s[12:15], s28 offen nt
    s_xor_b32 s28, s26, 0x59dc00
    v_and_b32_dpp v32, v70, v4 quad_perm:[0,0,0,0] row_mask:0xf bank_mask:0xf
    v_and_b32_dpp v33, v70, v5 quad_perm:[0,0,0,0] row_mask:0xf bank_mask:0xf
    s_nop 1
    v_mfma_f32_16x16x16_bf16 v[36:39], v[32:33], v[92:93], v[36:39]
    v_mfma_f32_16x16x16_bf16 v[40:43], v[32:33], v[94:95], v[40:43]
    s_waitcnt lgkmcnt(0)
    v_cmp_lt_i32 vcc, 0, v78
    v_mov_b32 v79, 124
    ds_write_b32 v76, v79 offset:16384
    ds_read_b32 v78, v77 offset:256
    s_waitcnt vmcnt(5)
    s_cbranch_vccnz L_w249
    s_waitcnt vmcnt(4)
L_w249:
    buffer_load_dwordx4 v[120:123], v2, s[12:15], s28 offen nt
    s_xor_b32 s28, s26, 0x529400
    v_and_b32_dpp v34, v70, v4 quad_perm:[1,1,1,1] row_mask:0xf bank_mask:0xf
    v_and_b32_dpp v35, v70, v5 quad_perm:[1,1,1,1] row_mask:0xf bank_mask:0xf
    s_nop 1
    v_mfma_f32_16x16x16_bf16 v[36:39], v[34:35], v[96:97], v[36:39]
    v_mfma_f32_16x16x16_bf16 v[40:43], v[34:35], v[98:99], v[40:43]
    s_waitcnt vmcnt(5)
    s_cbranch_vccnz L_w250
    s_waitcnt vmcnt(4)
L_w250:
    buffer_load_dwordx4 v[124:127], v2, s[12:15], s28 offen nt
    s_xor_b32 s28, s26, 0x5a9000
    v_and_b32_dpp v32, v70, v4 quad_perm:[2,2,2,2] row_mask:0xf bank_mask:0xf
    v_and_b32_dpp v33, v70, v5 quad_perm:[2,2,2,2] row_mask:0xf bank_mask:0xf
    s_nop 1
    v_mfma_f32_16x16x16_bf16 v[36:39], v[32:33], v[100:101], v[36:39]
    v_mfma_f32_16x16x16_bf16 v[40:43], v[32:33], v[102:103], v[40:43]
    s_waitcnt lgkmcnt(0)
    v_cmp_lt_i32 vcc, 2, v78
    v_mov_b32 v79, 125
    ds_write_b32 v76, v79 offset:16384
    ds_read_b32 v78, v77 offset:256
    s_waitcnt vmcnt(5)
    s_cbranch_vccnz L_w251
    s_waitcnt vmcnt(4)
L_w251:
    buffer_load_dwordx4 v[128:131], v2, s[12:15], s28 offen nt
    s_xor_b32 s28, s26, 0x529c00
    v_and_b32_dpp v34, v70, v4 quad_perm:[3,3,3,3] row_mask:0xf bank_mask:0xf
    v_and_b32_dpp v35, v70, v5 quad_perm:[3,3,3,3] row_mask:0xf bank_mask:0xf
    s_nop 1
    v_mfma_f32_16x16x16_bf16 v[36:39], v[34:35], v[104:105], v[36:39]
    v_mfma_f32_16x16x16_bf16 v[40:43], v[34:35], v[106:107], v[40:43]
    s_waitcnt vmcnt(5)
    s_cbranch_vccnz L_w252
    s_waitcnt vmcnt(4)
L_w252:
    buffer_load_dwordx4 v[132:135], v2, s[12:15], s28 offen nt
    s_xor_b32 s28, s26, 0x5a9800
    v_and_b32_dpp v32, v71, v4 quad_perm:[0,0,0,0] row_mask:0xf bank_mask:0xf
    v_and_b32_dpp v33, v71, v5 quad_perm:[0,0,0,0] row_mask:0xf bank_mask:0xf
    s_nop 1
    v_mfma_f32_16x16x16_bf16 v[36:39], v[32:33], v[108:109], v[36:39]
    v_mfma_f32_16x16x16_bf16 v[40:43], v[32:33], v[110:111], v[40:43]
    s_waitcnt lgkmcnt(0)
    v_cmp_lt_i32 vcc, 1, v78
    v_mov_b32 v79, 126
    ds_write_b32 v76, v79 offset:16384
    ds_read_b32 v78, v77 offset:256
    s_waitcnt vmcnt(5)
    s_cbranch_vccnz L_w253
    s_waitcnt vmcnt(4)
L_w253:
    buffer_load_dwordx4 v[136:139], v2, s[12:15], s28 offen nt
    s_xor_b32 s28, s26, 0x52d400
    v_and_b32_dpp v34, v71, v4 quad_perm:[1,1,1,1] row_mask:0xf bank_mask:0xf
    v_and_b32_dpp v35, v71, v5 quad_perm:[1,1,1,1] row_mask:0xf bank_mask:0xf
    s_nop 1
    v_mfma_f32_16x16x16_bf16 v[36:39], v[34:35], v[112:113], v[36:39]
    v_mfma_f32_16x16x16_bf16 v[40:43], v[34:35], v[114:115], v[40:43]
    s_waitcnt vmcnt(5)
    s_cbranch_vccnz L_w254
    s_waitcnt vmcnt(4)
L_w254:
    buffer_load_dwordx4 v[140:143], v2, s[12:15], s28 offen nt
    s_xor_b32 s28, s26, 0x5ad000
    v_and_b32_dpp v32, v71, v4 quad_perm:[2,2,2,2] row_mask:0xf bank_mask:0xf
    v_and_b32_dpp v33, v71, v5 quad_perm:[2,2,2,2] row_mask:0xf bank_mask:0xf
    s_nop 1
    v_mfma_f32_16x16x16_bf16 v[36:39], v[32:33], v[116:117], v[36:39]
    v_mfma_f32_16x16x16_bf16 v[40:43], v[32:33], v[118:119], v[40:43]
    s_waitcnt lgkmcnt(0)
    v_cmp_lt_i32 vcc, 3, v78
    v_mov_b32 v79, 127
    ds_write_b32 v76, v79 offset:16384
    ds_read_b32 v78, v77 offset:256
    s_waitcnt vmcnt(5)
    s_cbranch_vccnz L_w255
    s_waitcnt vmcnt(4)
L_w255:
    buffer_load_dwordx4 v[144:147], v2, s[12:15], s28 offen nt
    s_xor_b32 s28, s26, 0x52dc00
    v_and_b32_dpp v34, v71, v4 quad_perm:[3,3,3,3] row_mask:0xf bank_mask:0xf
    v_and_b32_dpp v35, v71, v5 quad_perm:[3,3,3,3] row_mask:0xf bank_mask:0xf
    s_nop 1
    v_mfma_f32_16x16x16_bf16 v[36:39], v[34:35], v[120:121], v[36:39]
    v_mfma_f32_16x16x16_bf16 v[40:43], v[34:35], v[122:123], v[40:43]
    s_waitcnt vmcnt(5)
    s_cbranch_vccnz L_w256
    s_waitcnt vmcnt(4)
L_w256:
    buffer_load_dwordx4 v[148:151], v2, s[12:15], s28 offen nt
    s_xor_b32 s28, s26, 0x5ad800
    v_and_b32_dpp v32, v72, v4 quad_perm:[0,0,0,0] row_mask:0xf bank_mask:0xf
    v_and_b32_dpp v33, v72, v5 quad_perm:[0,0,0,0] row_mask:0xf bank_mask:0xf
    s_nop 1
    v_mfma_f32_16x16x16_bf16 v[36:39], v[32:33], v[124:125], v[36:39]
    v_mfma_f32_16x16x16_bf16 v[40:43], v[32:33], v[126:127], v[40:43]
    s_waitcnt lgkmcnt(0)
    v_cmp_lt_i32 vcc, 0, v78
    v_mov_b32 v79, 128
    ds_write_b32 v76, v79 offset:16384
    ds_read_b32 v78, v77 offset:256
    s_waitcnt vmcnt(5)
    s_cbranch_vccnz L_w257
    s_waitcnt vmcnt(4)
L_w257:
    buffer_load_dwordx4 v[152:155], v2, s[12:15], s28 offen nt
    s_xor_b32 s28, s26, 0x539400
    v_and_b32_dpp v34, v72, v4 quad_perm:[1,1,1,1] row_mask:0xf bank_mask:0xf
    v_and_b32_dpp v35, v72, v5 quad_perm:[1,1,1,1] row_mask:0xf bank_mask:0xf
    s_nop 1
    v_mfma_f32_16x16x16_bf16 v[36:39], v[34:35], v[128:129], v[36:39]
    v_mfma_f32_16x16x16_bf16 v[40:43], v[34:35], v[130:131], v[40:43]
L_pad30:
    s_cmp_eq_u32 s51, 1
    s_cbranch_scc1 L_pad31
    s_waitcnt vmcnt(5)
    s_cbranch_vccnz L_w258
    s_waitcnt vmcnt(4)
L_w258:
    buffer_load_dwordx4 v[156:159], v2, s[12:15], s28 offen nt
    s_xor_b32 s28, s26, 0x5b9000
    v_and_b32_dpp v32, v72, v4 quad_perm:[2,2,2,2] row_mask:0xf bank_mask:0xf
    v_and_b32_dpp v33, v72, v5 quad_perm:[2,2,2,2] row_mask:0xf bank_mask:0xf
    s_nop 1
    v_mfma_f32_16x16x16_bf16 v[36:39], v[32:33], v[132:133], v[36:39]
    v_mfma_f32_16x16x16_bf16 v[40:43], v[32:33], v[134:135], v[40:43]
    s_waitcnt lgkmcnt(0)
    v_cmp_lt_i32 vcc, 2, v78
    v_mov_b32 v79, 129
    ds_write_b32 v76, v79 offset:16384
    ds_read_b32 v78, v77 offset:256
    s_cbranch_vccnz L_w259
    s_waitcnt vmcnt(6)
L_w259:
    buffer_load_dwordx4 v[160:163], v2, s[12:15], s28 offen nt
    s_xor_b32 s28, s26, 0x539c00
    s_cbranch_vccnz L_w260
    s_waitcnt vmcnt(6)
L_w260:
    buffer_load_dwordx4 v[164:167], v2, s[12:15], s28 offen nt
    s_xor_b32 s28, s26, 0x5b9800
    s_waitcnt lgkmcnt(0)
    v_cmp_lt_i32 vcc, 2, v78
    v_mov_b32 v79, 130
    ds_write_b32 v76, v79 offset:16384
    ds_read_b32 v78, v77 offset:256
    s_cbranch_vccnz L_w261
    s_waitcnt vmcnt(6)
L_w261:
    buffer_load_dwordx4 v[168:171], v2, s[12:15], s28 offen nt
    s_xor_b32 s28, s26, 0x53d400
    s_waitcnt vmcnt(8)
    s_cbranch_vccnz L_w262
    s_waitcnt vmcnt(6)
L_w262:
    buffer_load_dwordx4 v[172:175], v2, s[12:15], s28 offen nt
    s_xor_b32 s28, s26, 0x5bd000
    v_and_b32_dpp v34, v72, v4 quad_perm:[3,3,3,3] row_mask:0xf bank_mask:0xf
    v_and_b32_dpp v35, v72, v5 quad_perm:[3,3,3,3] row_mask:0xf bank_mask:0xf
    s_nop 1
    v_mfma_f32_16x16x16_bf16 v[36:39], v[34:35], v[136:137], v[36:39]
    v_mfma_f32_16x16x16_bf16 v[40:43], v[34:35], v[138:139], v[40:43]
    s_waitcnt lgkmcnt(0)
    v_cmp_lt_i32 vcc, 2, v78
    v_mov_b32 v79, 131
    ds_write_b32 v76, v79 offset:16384
    ds_read_b32 v78, v77 offset:256
    s_waitcnt vmcnt(8)
    s_cbranch_vccnz L_w263
    s_waitcnt vmcnt(6)
L_w263:
    buffer_load_dwordx4 v[176:179], v2, s[12:15], s28 offen nt
    s_xor_b32 s28, s26, 0x53dc00
    v_and_b32_dpp v32, v73, v4 quad_perm:[0,0,0,0] row_mask:0xf bank_mask:0xf
    v_and_b32_dpp v33, v73, v5 quad_perm:[0,0,0,0] row_mask:0xf bank_mask:0xf
    s_nop 1
    v_mfma_f32_16x16x16_bf16 v[36:39], v[32:33], v[140:141], v[36:39]
    v_mfma_f32_16x16x16_bf16 v[40:43], v[32:33], v[142:143], v[40:43]
    s_waitcnt vmcnt(8)
    s_cbranch_vccnz L_w264
    s_waitcnt vmcnt(6)
L_w264:
    buffer_load_dwordx4 v[180:183], v2, s[12:15], s28 offen nt
    s_xor_b32 s28, s26, 0x5bd800
    v_and_b32_dpp v34, v73, v4 quad_perm:[1,1,1,1] row_mask:0xf bank_mask:0xf
    v_and_b32_dpp v35, v73, v5 quad_perm:[1,1,1,1] row_mask:0xf bank_mask:0xf
    s_nop 1
    v_mfma_f32_16x16x16_bf16 v[36:39], v[34:35], v[144:145], v[36:39]
    v_mfma_f32_16x16x16_bf16 v[40:43], v[34:35], v[146:147], v[40:43]
    s_waitcnt lgkmcnt(0)
    v_cmp_lt_i32 vcc, 2, v78
    v_mov_b32 v79, 132
    ds_write_b32 v76, v79 offset:16384
    ds_read_b32 v78, v77 offset:256
    s_waitcnt vmcnt(8)
    s_cbranch_vccnz L_w265
    s_waitcnt vmcnt(6)
L_w265:
    buffer_load_dwordx4 v[184:187], v2, s[12:15], s28 offen nt
    v_and_b32_dpp v32, v73, v4 quad_perm:[2,2,2,2] row_mask:0xf bank_mask:0xf
    v_and_b32_dpp v33, v73, v5 quad_perm:[2,2,2,2] row_mask:0xf bank_mask:0xf
    s_nop 1
    v_mfma_f32_16x16x16_bf16 v[36:39], v[32:33], v[148:149], v[36:39]
    v_mfma_f32_16x16x16_bf16 v[40:43], v[32:33], v[150:151], v[40:43]
    v_and_b32_dpp v34, v73, v4 quad_perm:[3,3,3,3] row_mask:0xf bank_mask:0xf
    v_and_b32_dpp v35, v73, v5 quad_perm:[3,3,3,3] row_mask:0xf bank_mask:0xf
    s_nop 0
    s_waitcnt vmcnt(8)
    v_mfma_f32_16x16x16_bf16 v[36:39], v[34:35], v[152:153], v[36:39]
    v_mfma_f32_16x16x16_bf16 v[40:43], v[34:35], v[154:155], v[40:43]
    v_and_b32_dpp v32, v74, v4 quad_perm:[0,0,0,0] row_mask:0xf bank_mask:0xf
    v_and_b32_dpp v33, v74, v5 quad_perm:[0,0,0,0] row_mask:0xf bank_mask:0xf
    s_nop 0
    s_waitcnt vmcnt(7)
    v_mfma_f32_16x16x16_bf16 v[36:39], v[32:33], v[156:157], v[36:39]
    v_mfma_f32_16x16x16_bf16 v[40:43], v[32:33], v[158:159], v[40:43]
    v_and_b32_dpp v34, v74, v4 quad_perm:[1,1,1,1] row_mask:0xf bank_mask:0xf
    v_and_b32_dpp v35, v74, v5 quad_perm:[1,1,1,1] row_mask:0xf bank_mask:0xf
    s_nop 0
    s_waitcnt vmcnt(6)
    v_mfma_f32_16x16x16_bf16 v[36:39], v[34:35], v[160:161], v[36:39]
    v_mfma_f32_16x16x16_bf16 v[40:43], v[34:35], v[162:163], v[40:43]
    v_and_b32_dpp v32, v74, v4 quad_perm:[2,2,2,2] row_mask:0xf bank_mask:0xf
    v_and_b32_dpp v33, v74, v5 quad_perm:[2,2,2,2] row_mask:0xf bank_mask:0xf
    s_nop 0
    s_waitcnt vmcnt(5)
    v_mfma_f32_16x16x16_bf16 v[36:39], v[32:33], v[164:165], v[36:39]
    v_mfma_f32_16x16x16_bf16 v[40:43], v[32:33], v[166:167], v[40:43]
    v_and_b32_dpp v34, v74, v4 quad_perm:[3,3,3,3] row_mask:0xf bank_mask:0xf
    v_and_b32_dpp v35, v74, v5 quad_perm:[3,3,3,3] row_mask:0xf bank_mask:0xf
    s_nop 0
    s_waitcnt vmcnt(4)
    v_mfma_f32_16x16x16_bf16 v[36:39], v[34:35], v[168:169], v[36:39]
    v_mfma_f32_16x16x16_bf16 v[40:43], v[34:35], v[170:171], v[40:43]
    v_and_b32_dpp v32, v75, v4 quad_perm:[0,0,0,0] row_mask:0xf bank_mask:0xf
    v_and_b32_dpp v33, v75, v5 quad_perm:[0,0,0,0] row_mask:0xf bank_mask:0xf
    s_nop 0
    s_waitcnt vmcnt(3)
    v_mfma_f32_16x16x16_bf16 v[36:39], v[32:33], v[172:173], v[36:39]
    v_mfma_f32_16x16x16_bf16 v[40:43], v[32:33], v[174:175], v[40:43]
    buffer_load_dwordx4 v[188:191], v231, s[20:23], s30 offen nt
    s_add_u32 s30, s30, 4096
    buffer_load_dwordx4 v[192:195], v231, s[20:23], s30 offen nt
    s_add_u32 s30, s30, 4096
    buffer_load_dwordx4 v[196:199], v231, s[20:23], s30 offen nt
    s_add_u32 s30, s30, 4096
    buffer_load_dwordx4 v[200:203], v231, s[20:23], s30 offen nt
    v_and_b32_dpp v34, v75, v4 quad_perm:[1,1,1,1] row_mask:0xf bank_mask:0xf
    v_and_b32_dpp v35, v75, v5 quad_perm:[1,1,1,1] row_mask:0xf bank_mask:0xf
    s_nop 0
    s_waitcnt vmcnt(6)
    v_mfma_f32_16x16x16_bf16 v[36:39], v[34:35], v[176:177], v[36:39]
    v_mfma_f32_16x16x16_bf16 v[40:43], v[34:35], v[178:179], v[40:43]
    v_and_b32_dpp v32, v75, v4 quad_perm:[2,2,2,2] row_mask:0xf bank_mask:0xf
    v_and_b32_dpp v33, v75, v5 quad_perm:[2,2,2,2] row_mask:0xf bank_mask:0xf
    s_nop 0
    s_waitcnt vmcnt(5)
    v_mfma_f32_16x16x16_bf16 v[36:39], v[32:33], v[180:181], v[36:39]
    v_mfma_f32_16x16x16_bf16 v[40:43], v[32:33], v[182:183], v[40:43]
    v_and_b32_dpp v34, v75, v4 quad_perm:[3,3,3,3] row_mask:0xf bank_mask:0xf
    v_and_b32_dpp v35, v75, v5 quad_perm:[3,3,3,3] row_mask:0xf bank_mask:0xf
    s_nop 0
    s_waitcnt vmcnt(4)
    v_mfma_f32_16x16x16_bf16 v[36:39], v[34:35], v[184:185], v[36:39]
    v_mfma_f32_16x16x16_bf16 v[40:43], v[34:35], v[186:187], v[40:43]
    s_nop 6
    ds_write_b128 v227, v[36:39] offset:4096
    ds_write_b128 v227, v[40:43] offset:4112
    s_cmp_eq_u32 s3, 0
    s_waitcnt lgkmcnt(0)
    s_barrier
    s_cbranch_scc0 L_noc
    ds_read_b128 v[12:15], v2 offset:12288
L_noc:
L_poll4:
    buffer_load_dwordx4 v[232:235], v226, s[16:19], s31 offen sc1
    buffer_load_dwordx4 v[236:239], v226, s[16:19], s33 offen sc1
    s_waitcnt vmcnt(1)
    v_xor_b32 v232, s37, v232
    v_xor_b32 v233, s38, v233
    v_xor_b32 v234, s39, v234
    v_xor_b32 v235, s40, v235
    v_or_b32 v246, v232, v233
    v_or3_b32 v246, v234, v235, v246
    s_waitcnt vmcnt(0)
    v_xor_b32 v236, s37, v236
    v_xor_b32 v237, s38, v237
    v_xor_b32 v238, s39, v238
    v_xor_b32 v239, s40, v239
    v_or3_b32 v246, v236, v237, v246
    v_or3_b32 v246, v238, v239, v246
    v_cmp_ne_u32_sdwa vcc, v246, 0 src0_sel:BYTE_0 src1_sel:DWORD
    v_pk_add_f32 v[232:233], v[232:233], v[236:237]
    v_pk_add_f32 v[234:235], v[234:235], v[238:239]
    s_cbranch_vccnz L_retry4
L_pollx4:
    s_mov_b64 exec, -1
    s_cmp_eq_u32 s49, 0
    s_cbranch_scc1 L_sf
L_nf:
    v_permlane32_swap_b32 v232, v234
    v_permlane32_swap_b32 v233, v235
    v_add_f32 v232, v232, v234
    v_add_f32 v233, v233, v235
    s_waitcnt lgkmcnt(0)
    s_cmp_eq_u32 s3, 0
    v_permlane16_swap_b32 v232, v233
    v_add_f32 v232, v232, v233
    s_nop 1
    v_add_f32_dpp v232, v232, v232 row_ror:8 row_mask:0xf bank_mask:0xf
    v_cvt_pk_bf16_f32 v244, v232, v232
    s_nop 1
    v_and_b32_dpp v44, v244, v216 quad_perm:[0,0,0,0] row_mask:0xf bank_mask:0xf
    v_and_b32_dpp v45, v244, v217 quad_perm:[0,0,0,0] row_mask:0xf bank_mask:0xf
    v_and_b32_dpp v46, v244, v218 quad_perm:[0,0,0,0] row_mask:0xf bank_mask:0xf
    v_and_b32_dpp v47, v244, v219 quad_perm:[0,0,0,0] row_mask:0xf bank_mask:0xf
    v_and_b32_dpp v48, v244, v216 quad_perm:[1,1,1,1] row_mask:0xf bank_mask:0xf
    v_and_b32_dpp v49, v244, v217 quad_perm:[1,1,1,1] row_mask:0xf bank_mask:0xf
    v_and_b32_dpp v50, v244, v218 quad_perm:[1,1,1,1] row_mask:0xf bank_mask:0xf
    v_and_b32_dpp v51, v244, v219 quad_perm:[1,1,1,1] row_mask:0xf bank_mask:0xf
    v_mfma_f32_16x16x32_bf16 v[12:15], v[44:47], v[188:191], v[12:15]
    v_and_b32_dpp v52, v244, v216 quad_perm:[2,2,2,2] row_mask:0xf bank_mask:0xf
    v_and_b32_dpp v53, v244, v217 quad_perm:[2,2,2,2] row_mask:0xf bank_mask:0xf
    v_and_b32_dpp v54, v244, v218 quad_perm:[2,2,2,2] row_mask:0xf bank_mask:0xf
    v_and_b32_dpp v55, v244, v219 quad_perm:[2,2,2,2] row_mask:0xf bank_mask:0xf
    v_mfma_f32_16x16x32_bf16 v[12:15], v[48:51], v[192:195], v[12:15]
    v_and_b32_dpp v56, v244, v216 quad_perm:[3,3,3,3] row_mask:0xf bank_mask:0xf
    v_and_b32_dpp v57, v244, v217 quad_perm:[3,3,3,3] row_mask:0xf bank_mask:0xf
    v_and_b32_dpp v58, v244, v218 quad_perm:[3,3,3,3] row_mask:0xf bank_mask:0xf
    v_and_b32_dpp v59, v244, v219 quad_perm:[3,3,3,3] row_mask:0xf bank_mask:0xf
    v_mfma_f32_16x16x32_bf16 v[12:15], v[52:55], v[196:199], v[12:15]
    s_nop 0
    v_mfma_f32_16x16x32_bf16 v[12:15], v[56:59], v[200:203], v[12:15]
    s_cbranch_scc1 L_s0
    s_nop 6
    ds_write_b128 v1, v[12:15] offset:12288
    s_waitcnt lgkmcnt(0)
    s_barrier
    s_endpgm
L_s0:
    s_barrier
    ds_read_b128 v[44:47], v2 offset:13312
    ds_read_b128 v[48:51], v2 offset:14336
    ds_read_b128 v[52:55], v2 offset:15360
    s_waitcnt lgkmcnt(2)
    s_nop 1
    v_pk_add_f32 v[12:13], v[12:13], v[44:45]
    v_pk_add_f32 v[14:15], v[14:15], v[46:47]
    s_waitcnt lgkmcnt(1)
    v_pk_add_f32 v[12:13], v[12:13], v[48:49]
    v_pk_add_f32 v[14:15], v[14:15], v[50:51]
    s_waitcnt lgkmcnt(0)
    v_pk_add_f32 v[12:13], v[12:13], v[52:53]
    v_pk_add_f32 v[14:15], v[14:15], v[54:55]
    v_and_or_b32 v12, v12, v230, s37
    v_and_or_b32 v13, v13, v230, s38
    v_and_or_b32 v14, v14, v230, s39
    v_and_or_b32 v15, v15, v230, s40
    buffer_store_dwordx4 v[12:15], v2, s[16:19], s32 offen sc1
    s_endpgm
L_retry4:
    s_wqm_b64 exec, vcc
    s_sub_u32 s50, s50, 1
    s_cbranch_scc0 L_poll4
    s_branch L_pollx4
L_sf:
    s_mov_b64 exec, 1
    buffer_store_dword v228, v229, s[16:19], s48 offen sc1
    s_mov_b64 exec, -1
    s_branch L_nf
L_pad31:
    s_cmp_eq_u32 s51, 1
    s_cbranch_scc1 L_padret
L_end:
    s_endpgm
.section .rodata,"a"
.p2align 6
.amdhsa_kernel parallel_sum__gqa_block_cached__geglu_ffn__decode_kernel
  .amdhsa_next_free_vgpr 256
  .amdhsa_next_free_sgpr 96
  .amdhsa_accum_offset 256
  .amdhsa_group_segment_fixed_size 0
  .amdhsa_kernarg_size 96
  .amdhsa_user_sgpr_count 2
  .amdhsa_user_sgpr_kernarg_segment_ptr 1
  .amdhsa_system_sgpr_workgroup_id_x 1
.end_amdhsa_kernel
```
